```python
import torch

def _softmax(x, axis=-1):
    return torch.softmax(x, dim=axis)
def _gelu(x):
    return torch.nn.functional.gelu(x, approximate="tanh")
def _silu(x):
    return torch.nn.functional.silu(x)
def _sigmoid(x):
    return torch.sigmoid(x)
def _layernorm(x, axis=-1, eps=1e-5):
    m = x.mean(dim=axis, keepdim=True)
    v = x.var(dim=axis, keepdim=True, unbiased=False)
    return (x - m) / torch.sqrt(v + eps)
def _scatter_add(tgt, idx, src, axis=0):
    return tgt.clone().index_add_(axis, idx, src)
def _segment_sum(src, seg, n):
    out = torch.zeros((n,) + src.shape[1:], dtype=src.dtype)
    return out.index_add_(0, seg, src)
def _pad(x, pw):
    flat = tuple(v for pair in reversed(pw) for v in pair)
    return torch.nn.functional.pad(x, flat)

kernel_name = 'recurrent_scan__mha_block__glu_gated_glu__prompt'

def setup_inputs():

    _w = (lambda a: (lambda t: t.to(torch.bfloat16) if t.is_floating_point() else t)(torch.as_tensor(a)))
    def _A_setup():
        B, S, D, H = 1, 2048, 448, 16
        return {
            "x": _w((lambda *s: torch.randn(*s, dtype=torch.bfloat16) * 0.05)(B, S, D)),
            "wqkv": _w((lambda *s: torch.randn(*s, dtype=torch.bfloat16) * 0.05)(D, 3 * D)),
            "wo": _w((lambda *s: torch.randn(*s, dtype=torch.bfloat16) * 0.05)(D, D)),
        }
    _A_in = _A_setup()

    def _B_setup():
        B, S, D, F = 1, 2048, 448, 1792
        return {
            "x": _w((lambda *s: torch.randn(*s, dtype=torch.bfloat16) * 0.05)(B, S, D)),
            "w_gate": _w((lambda *s: torch.randn(*s, dtype=torch.bfloat16) * 0.05)(D, F)),
            "w_up": _w((lambda *s: torch.randn(*s, dtype=torch.bfloat16) * 0.05)(D, F)),
            "w_down": _w((lambda *s: torch.randn(*s, dtype=torch.bfloat16) * 0.05)(F, D)),
        }
    _B_in = _B_setup()

    return {
        "A_x": _A_in["x"],
        "A_wqkv": _A_in["wqkv"],
        "A_wo": _A_in["wo"],
        "B_x": _B_in["x"],
        "B_w_gate": _B_in["w_gate"],
        "B_w_up": _B_in["w_up"],
        "B_w_down": _B_in["w_down"],
    }

def reference(A_x, A_wqkv, A_wo, B_x, B_w_gate, B_w_up, B_w_down):
    def _A_ref(x, wqkv, wo):
        B, S, D = x.shape
        H = 16
        Dh = D // H
        qkv = (lambda x, *d: x.permute(*d))((x @ wqkv).reshape(B, S, 3, H, Dh), 2, 0, 3, 1, 4)
        q, k, v = qkv[0], qkv[1], qkv[2]
        scores = torch.einsum("bhqd,bhkd->bhqk", q, k) * (Dh ** -0.5)
        p = _softmax(scores, axis=-1)
        o = torch.einsum("bhqk,bhkd->bhqd", p, v)
        return (lambda x, *d: x.permute(*d))(o, 0, 2, 1, 3).reshape(B, S, D) @ wo

    def _B_ref(x, w_gate, w_up, w_down):
        g = torch.einsum("bsd,df->bsf", x, w_gate)
        u = torch.einsum("bsd,df->bsf", x, w_up)
        h = _sigmoid(g) * u
        return torch.einsum("bsf,fd->bsd", h, w_down)

    x = A_x
    xn = _layernorm(x, axis=-1)
    s = _A_ref(xn, A_wqkv, A_wo)
    g = _silu(_B_ref(xn, B_w_gate, B_w_up, B_w_down))
    return x + s * g
```

```asm
; @launch kernel=fz_kernel grid=(256,1,1) block=(512,1,1) lds=163840
.amdgcn_target "amdgcn-amd-amdhsa--gfx950"
.text
.globl fz_kernel
.p2align 8
.type fz_kernel,@function
fz_kernel:
    s_cmp_ge_u32 s2, 256
    s_cbranch_scc1 fz_end
    s_load_dwordx16 s[4:19], s[0:1], 0
    s_load_dwordx4 s[20:23], s[0:1], 64
    s_cmp_ge_u32 s2, 64
    s_cbranch_scc1 fz_pf1
    s_getpc_b64 s[62:63]
fz_pf0:
    v_lshlrev_b32 v47, 7, v0
    v_min_u32 v47, fz_end-fz_pf0, v47
    global_load_dword v47, v47, s[62:63]
fz_pf1:
    v_lshrrev_b32 v2, 6, v0
    v_and_b32 v1, 63, v0
    v_readfirstlane_b32 s50, v2
    s_and_b32 s98, s2, 7
    s_lshr_b32 s54, s2, 3
    s_and_b32 s48, s98, 1
    s_lshl_b32 s48, s48, 3
    s_and_b32 s62, s54, 7
    s_add_u32 s48, s48, s62
    s_lshr_b32 s49, s98, 1
    s_lshl_b32 s49, s49, 2
    s_lshr_b32 s62, s54, 3
    s_add_u32 s49, s49, s62
    s_and_b32 s58, s50, 3
    s_lshl_b32 s51, s58, 10
    s_lshl_b32 s62, s62, 1
    s_and_b32 s99, s54, 7
    s_add_u32 s99, s99, s62
    s_sub_u32 s62, s99, 7
    s_cselect_b32 s99, s99, s62
    s_lshl_b32 s52, s99, 7
    s_mul_i32 s53, s99, 172032
    v_bfe_u32 v16, v1, 2, 3
    s_lshl_b32 s61, s58, 3
    v_add_u32 v16, s61, v16
    v_bfe_u32 v17, v16, 2, 2
    v_and_b32 v18, 3, v1
    v_xor_b32 v17, v17, v18
    v_lshrrev_b32 v18, 5, v1
    v_lshl_add_u32 v17, v18, 2, v17
    v_mul_u32_u24 v16, 896, v16
    v_lshl_add_u32 v4, v17, 4, v16
    s_mul_i32 s63, s48, 114688
    s_cmp_ge_u32 s50, 4
    s_cbranch_scc0 fz_a0
fz_gh:
    s_mul_i32 s61, s49, 7
    s_lshr_b32 s61, s61, 1
    s_lshl_b32 s61, s61, 4
    v_lshrrev_b32 v16, 2, v1
    s_lshl_b32 s62, s58, 4
    v_add_u32 v16, s62, v16
    v_and_b32 v17, 3, v1
    v_mul_u32_u24 v16, 2688, v16
    v_lshl_add_u32 v16, v17, 4, v16
    v_add_u32 v5, s61, v16
    v_add_u32 v123, 28672, v4
    v_add_u32 v124, 57344, v4
    v_add_u32 v125, 86016, v4
    s_setprio 3
    s_waitcnt lgkmcnt(0)
    s_add_u32 s24, s4, s63
    s_addc_u32 s25, s5, 0
    s_mov_b32 s26, 114688
    s_mov_b32 s27, 0x20000
    s_mov_b32 s28, s6
    s_mov_b32 s29, s7
    s_mov_b32 s30, 1204224
    s_mov_b32 s31, 0x20000
    s_add_u32 m0, s51, 73728
    s_nop 0
    buffer_load_dwordx4 v124, s[24:27], s52 offen lds
    s_add_u32 m0, s51, 77824
    s_nop 0
    buffer_load_dwordx4 v125, s[24:27], s52 offen lds
    s_add_u32 m0, s51, 8192
    s_nop 0
    buffer_load_dwordx4 v5, s[28:31], s53 offen lds
    s_add_u32 s52, s52, 128
    s_add_u32 s53, s53, 172032
    s_cmp_eq_u32 s52, 896
    s_cselect_b32 s52, 0, s52
    s_cselect_b32 s53, 0, s53
    s_branch fz_g
fz_a0:
    s_add_u32 s61, s49, 7
    s_lshl_b32 s61, s61, 7
    s_cmp_lt_u32 s49, 14
    s_cselect_b32 s61, s61, 1073741824
    v_lshrrev_b32 v16, 3, v1
    s_lshl_b32 s62, s58, 3
    v_add_u32 v16, s62, v16
    v_bfe_u32 v17, v16, 1, 1
    v_lshlrev_b32 v17, 2, v17
    v_and_b32 v18, 7, v1
    v_xor_b32 v17, v17, v18
    v_mul_u32_u24 v16, 2688, v16
    v_lshl_add_u32 v16, v17, 4, v16
    v_add_u32 v5, s61, v16
    v_add_u32 v175, 28672, v4
    v_add_u32 v176, 86016, v5
    s_setprio 3
    s_waitcnt lgkmcnt(0)
    s_add_u32 s24, s4, s63
    s_addc_u32 s25, s5, 0
    s_mov_b32 s26, 114688
    s_mov_b32 s27, 0x20000
    s_mov_b32 s28, s6
    s_mov_b32 s29, s7
    s_mov_b32 s30, 1204224
    s_mov_b32 s31, 0x20000
    s_add_u32 m0, s51, 65536
    s_nop 0
    buffer_load_dwordx4 v4, s[24:27], s52 offen lds
    s_add_u32 m0, s51, 69632
    s_nop 0
    buffer_load_dwordx4 v175, s[24:27], s52 offen lds
    s_add_u32 m0, s51, 0
    s_nop 0
    buffer_load_dwordx4 v5, s[28:31], s53 offen lds
    s_add_u32 m0, s51, 4096
    s_nop 0
    buffer_load_dwordx4 v176, s[28:31], s53 offen lds
    s_add_u32 s52, s52, 128
    s_add_u32 s53, s53, 172032
    s_cmp_eq_u32 s52, 896
    s_cselect_b32 s52, 0, s52
    s_cselect_b32 s53, 0, s53
    s_mov_b32 s40, s22
    s_mov_b32 s41, s23
    s_mov_b32 s42, 268435456
    s_mov_b32 s43, 0x20000
    s_sub_u32 s78, s49, 14
    s_lshl_b32 s78, s78, 4
    s_add_u32 s78, s78, s48
    s_cmp_eq_u32 s50, 3
    s_cselect_b32 s78, s78, 64
    s_cmp_ge_u32 s78, 32
    s_cbranch_scc1 clr_1_a
    s_lshl_b32 s79, s78, 12
    s_add_u32 s79, s79, 16777216
    v_lshlrev_b32 v16, 4, v1
    v_mov_b32 v20, 0
    v_mov_b32 v21, 0
    v_mov_b32 v22, 0
    v_mov_b32 v23, 0
    v_lshrrev_b32 v17, 2, v1
    v_lshlrev_b32 v17, 7, v17
    v_and_b32 v18, 48, v16
    v_add_u32 v17, v17, v18
    buffer_store_dwordx4 v[20:23], v17, s[40:43], s79 offen offset:0 sc1
    buffer_store_dwordx4 v[20:23], v17, s[40:43], s79 offen offset:2048 sc1
    s_lshl_b32 s79, s78, 13
    s_add_u32 s79, s79, 16908288
    v_lshrrev_b32 v18, 1, v1
    v_lshlrev_b32 v18, 8, v18
    v_and_b32 v16, 16, v16
    v_add_u32 v16, v16, v18
    buffer_store_dwordx4 v[20:23], v16, s[40:43], s79 offen sc1
    buffer_store_dwordx4 v[20:23], v16, s[40:43], s79 offen offset:128 sc1
clr_1_a:
    s_setprio 2
    s_add_u32 m0, s51, 81920
    s_nop 0
    buffer_load_dwordx4 v4, s[24:27], s52 offen lds
    s_mov_b32 s44, s20
    s_mov_b32 s45, s21
    s_mov_b32 s46, 256
    s_mov_b32 s47, 0x20000
    s_mov_b32 s55, 0x3f803f80
    s_mov_b32 s56, 0
    s_mov_b32 s57, -1
    s_lshl_b32 s59, s48, 4
    s_add_u32 s59, s59, s49
    s_lshl_b32 s59, s59, 2
    v_lshlrev_b32 v16, 2, v1
    v_add_u32 v17, 163328, v16
    v_mov_b32 v6, 163072
    v_cmp_eq_u32 vcc, 0, v1
    s_add_u32 m0, s51, 86016
    s_nop 0
    buffer_load_dwordx4 v175, s[24:27], s52 offen lds
    v_cndmask_b32 v2, v17, v6, vcc
    v_mov_b32 v3, 1
    v_and_b32 v112, 31, v1
    v_lshrrev_b32 v113, 5, v1
    v_bfe_u32 v114, v1, 2, 2
    v_xor_b32 v115, v113, v114
    v_lshlrev_b32 v115, 4, v115
    v_and_b32 v116, 7, v1
    v_lshl_add_u32 v115, v116, 6, v115
    v_bfe_u32 v116, v1, 3, 2
    v_lshl_add_u32 v115, v116, 10, v115
    v_bfe_u32 v116, v1, 4, 1
    v_and_b32 v117, 3, v1
    s_add_u32 m0, s51, 16384
    s_nop 0
    buffer_load_dwordx4 v5, s[28:31], s53 offen lds
    v_lshlrev_b32 v117, 3, v117
    v_and_b32 v120, 15, v1
    v_bfe_u32 v121, v1, 4, 1
    v_lshlrev_b32 v121, 2, v121
    v_cmp_eq_u32 vcc, v120, v121
    v_mov_b32 v120, s55
    s_nop 0
    v_cndmask_b32 v240, 0, v120, vcc
    v_cndmask_b32 v241, 0, v120, vcc
    v_cndmask_b32 v242, 0, v120, vcc
    v_cndmask_b32 v243, 0, v120, vcc
    s_lshl_b32 s60, s50, 12
    s_add_u32 s60, s60, 65536
    s_lshr_b32 s61, s50, 1
    s_add_u32 m0, s51, 20480
    s_nop 0
    buffer_load_dwordx4 v176, s[28:31], s53 offen lds
    s_add_u32 s52, s52, 128
    s_add_u32 s53, s53, 172032
    s_cmp_eq_u32 s52, 896
    s_cselect_b32 s52, 0, s52
    s_cselect_b32 s53, 0, s53
    s_xor_b32 s61, s61, 1
    s_and_b32 s62, s50, 1
    s_lshl_b32 s64, s62, 1
    s_or_b32 s64, s64, s61
    s_lshl_b32 s61, s61, 5
    s_lshl_b32 s62, s62, 9
    s_or_b32 s61, s61, s62
    v_add_u32 v216, s60, v115
    v_xor_b32 v216, s61, v216
    v_xor_b32 v217, 32, v216
    v_xor_b32 v218, 512, v216
    v_xor_b32 v219, 512, v217
    v_lshl_add_u32 v118, v113, 3, v114
    s_setprio 1
    s_add_u32 m0, s51, 98304
    s_nop 0
    buffer_load_dwordx4 v4, s[24:27], s52 offen lds
    v_lshlrev_b32 v118, 7, v118
    v_lshrrev_b32 v119, 1, v114
    v_lshl_add_u32 v118, v119, 6, v118
    v_lshl_add_u32 v118, v116, 5, v118
    s_lshl_b32 s60, s64, 11
    v_add3_u32 v224, v118, v117, s60
    v_add_u32 v220, 65536, v216
    v_add_u32 v221, 65536, v217
    v_add_u32 v222, 65536, v218
    v_add_u32 v223, 65536, v219
    v_xor_b32 v225, 2048, v224
    v_xor_b32 v226, 4096, v224
    v_xor_b32 v227, 6144, v224
    v_xor_b32 v228, 64, v224
    s_add_u32 m0, s51, 102400
    s_nop 0
    buffer_load_dwordx4 v175, s[24:27], s52 offen lds
    v_xor_b32 v229, 64, v225
    v_xor_b32 v230, 64, v226
    v_xor_b32 v231, 64, v227
    v_lshlrev_b32 v15, 4, v1
    v_lshlrev_b32 v118, 2, v112
    s_lshl_b32 s60, s50, 8
    s_add_u32 s60, s60, 155648
    v_add_u32 v248, s60, v118
    v_lshl_add_u32 v119, v113, 8, v118
    v_add_u32 v250, 155648, v119
    v_lshlrev_b32 v119, 4, v113
    s_lshl_b32 s61, s50, 7
    s_add_u32 s61, s61, 156928
    s_add_u32 m0, s51, 32768
    s_nop 0
    buffer_load_dwordx4 v5, s[28:31], s53 offen lds
    v_add_u32 v174, s61, v118
    v_add_u32 v249, s61, v119
    v_mul_u32_u24 v119, 7168, v113
    v_lshl_add_u32 v119, v112, 4, v119
    v_add_u32 v251, 28672, v119
    s_and_b32 s60, s2, 1
    s_lshl_b32 s60, s60, 7
    v_add_u32 v253, s60, v118
    s_lshl_b32 s60, s48, 2
    s_add_u32 s60, s60, s50
    s_lshl_b32 s63, s60, 4
    s_add_u32 s63, s63, s49
    s_lshl_b32 s64, s63, 2
    s_add_u32 m0, s51, 36864
    s_nop 0
    buffer_load_dwordx4 v176, s[28:31], s53 offen lds
    s_add_u32 s52, s52, 128
    s_add_u32 s53, s53, 172032
    s_cmp_eq_u32 s52, 896
    s_cselect_b32 s52, 0, s52
    s_cselect_b32 s53, 0, s53
    s_andn2_b32 s61, s64, 31
    s_mul_i32 s61, s61, 3
    s_add_u32 s64, s64, s61
    s_add_u32 s64, s64, 17039360
    s_lshl_b32 s63, s63, 11
    s_add_u32 s63, s63, 14680064
    s_mul_i32 s60, s60, 57344
    s_lshl_b32 s61, s49, 12
    s_sub_u32 s72, s49, 7
    s_lshl_b32 s72, s72, 10
    s_cmp_lt_u32 s49, 7
    s_cselect_b32 s61, s61, s72
    s_add_u32 s70, s60, s61
    s_add_u32 s71, s70, 14336
    s_setprio 1
    s_cmp_lg_u32 s50, 0
    s_cbranch_scc1 clr_1_b
    v_lshlrev_b32 v16, 2, v1
    v_add_u32 v17, 163072, v16
    v_mov_b32 v20, 0
    ds_write_b32 v17, v20
clr_1_b:
    s_cmp_ge_u32 s78, 32
    s_cbranch_scc1 clr_1_c
    s_lshl_b32 s78, s78, 2
    v_lshlrev_b32 v17, 7, v1
    s_waitcnt vmcnt(8)
    s_mov_b64 exec, 3
    buffer_store_dword v3, v17, s[44:47], s78 offen sc1
    s_mov_b64 exec, -1
clr_1_c:
    s_sub_u32 s60, s49, 7
    s_cmp_lt_u32 s60, 7
    s_cbranch_scc1 fz_av
    s_waitcnt vmcnt(8) lgkmcnt(0)
    s_barrier
    ds_read_b128 v[112:115], v216 offset:0
    ds_read_b64_tr_b16 v[116:117], v224 offset:0
    ds_read_b64_tr_b16 v[118:119], v224 offset:512
    ds_read_b64_tr_b16 v[120:121], v228 offset:0
    ds_read_b64_tr_b16 v[122:123], v228 offset:512
    ds_read_b128 v[124:127], v217 offset:0
    ds_read_b64_tr_b16 v[128:129], v225 offset:0
    ds_read_b64_tr_b16 v[130:131], v225 offset:512
    ds_read_b64_tr_b16 v[132:133], v229 offset:0
    ds_read_b64_tr_b16 v[134:135], v229 offset:512
    ds_read_b128 v[136:139], v218 offset:0
    ds_read_b64_tr_b16 v[140:141], v226 offset:0
    ds_read_b64_tr_b16 v[142:143], v226 offset:512
    ds_read_b64_tr_b16 v[144:145], v230 offset:0
    ds_read_b64_tr_b16 v[146:147], v230 offset:512
    ds_read_b128 v[148:151], v219 offset:0
    ds_read_b64_tr_b16 v[152:153], v227 offset:0
    ds_read_b64_tr_b16 v[154:155], v227 offset:512
    ds_read_b64_tr_b16 v[156:157], v231 offset:0
    ds_read_b64_tr_b16 v[158:159], v231 offset:512
    s_waitcnt lgkmcnt(15)
    v_mfma_f32_32x32x16_bf16 v[16:31], v[116:119], v[112:115], 0
    s_waitcnt lgkmcnt(15)
    v_mfma_f32_32x32x16_bf16 v[32:47], v[120:123], v[112:115], 0
    v_mfma_f32_16x16x32_bf16 v[232:235], v[240:243], v[116:119], 0
    v_mfma_f32_16x16x32_bf16 v[236:239], v[240:243], v[120:123], 0
    s_waitcnt lgkmcnt(12)
    v_mfma_f32_32x32x16_bf16 v[16:31], v[128:131], v[124:127], v[16:31]
    s_waitcnt lgkmcnt(10)
    v_mfma_f32_32x32x16_bf16 v[32:47], v[132:135], v[124:127], v[32:47]
    s_waitcnt vmcnt(4) lgkmcnt(0)
    s_barrier
    v_mfma_f32_32x32x16_bf16 v[16:31], v[140:143], v[136:139], v[16:31]
    ds_read_b128 v[48:51], v216 offset:16384
    ds_read_b64_tr_b16 v[52:53], v224 offset:16384
    ds_read_b64_tr_b16 v[54:55], v224 offset:16896
    v_mfma_f32_32x32x16_bf16 v[32:47], v[144:147], v[136:139], v[32:47]
    ds_read_b64_tr_b16 v[56:57], v228 offset:16384
    ds_read_b64_tr_b16 v[58:59], v228 offset:16896
    v_mfma_f32_32x32x16_bf16 v[16:31], v[152:155], v[148:151], v[16:31]
    ds_read_b128 v[60:63], v217 offset:16384
    ds_read_b64_tr_b16 v[64:65], v225 offset:16384
    ds_read_b64_tr_b16 v[66:67], v225 offset:16896
    v_mfma_f32_32x32x16_bf16 v[32:47], v[156:159], v[148:151], v[32:47]
    ds_read_b64_tr_b16 v[68:69], v229 offset:16384
    ds_read_b64_tr_b16 v[70:71], v229 offset:16896
    s_waitcnt lgkmcnt(7)
    v_mfma_f32_32x32x16_bf16 v[16:31], v[52:55], v[48:51], v[16:31]
    ds_read_b128 v[72:75], v218 offset:16384
    ds_read_b64_tr_b16 v[76:77], v226 offset:16384
    ds_read_b64_tr_b16 v[78:79], v226 offset:16896
    s_waitcnt lgkmcnt(8)
    v_mfma_f32_32x32x16_bf16 v[32:47], v[56:59], v[48:51], v[32:47]
    ds_read_b64_tr_b16 v[80:81], v230 offset:16384
    ds_read_b64_tr_b16 v[82:83], v230 offset:16896
    v_mfma_f32_16x16x32_bf16 v[232:235], v[240:243], v[52:55], v[232:235]
    v_mfma_f32_16x16x32_bf16 v[236:239], v[240:243], v[56:59], v[236:239]
    s_waitcnt lgkmcnt(7)
    v_mfma_f32_32x32x16_bf16 v[16:31], v[64:67], v[60:63], v[16:31]
    ds_read_b128 v[84:87], v219 offset:16384
    ds_read_b64_tr_b16 v[88:89], v227 offset:16384
    ds_read_b64_tr_b16 v[90:91], v227 offset:16896
    ds_read_b64_tr_b16 v[92:93], v231 offset:16384
    ds_read_b64_tr_b16 v[94:95], v231 offset:16896
    s_waitcnt lgkmcnt(10)
    v_mfma_f32_32x32x16_bf16 v[32:47], v[68:71], v[60:63], v[32:47]
    s_waitcnt vmcnt(0) lgkmcnt(0)
    s_barrier
    v_mfma_f32_32x32x16_bf16 v[16:31], v[76:79], v[72:75], v[16:31]
    ds_read_b128 v[112:115], v216 offset:32768
    ds_read_b64_tr_b16 v[116:117], v224 offset:32768
    ds_read_b64_tr_b16 v[118:119], v224 offset:33280
    v_mfma_f32_32x32x16_bf16 v[32:47], v[80:83], v[72:75], v[32:47]
    ds_read_b64_tr_b16 v[120:121], v228 offset:32768
    ds_read_b64_tr_b16 v[122:123], v228 offset:33280
    v_mfma_f32_32x32x16_bf16 v[16:31], v[88:91], v[84:87], v[16:31]
    ds_read_b128 v[124:127], v217 offset:32768
    ds_read_b64_tr_b16 v[128:129], v225 offset:32768
    ds_read_b64_tr_b16 v[130:131], v225 offset:33280
    v_mfma_f32_32x32x16_bf16 v[32:47], v[92:95], v[84:87], v[32:47]
    ds_read_b64_tr_b16 v[132:133], v229 offset:32768
    ds_read_b64_tr_b16 v[134:135], v229 offset:33280
    s_waitcnt lgkmcnt(7)
    v_mfma_f32_32x32x16_bf16 v[16:31], v[116:119], v[112:115], v[16:31]
    ds_read_b128 v[136:139], v218 offset:32768
    ds_read_b64_tr_b16 v[140:141], v226 offset:32768
    ds_read_b64_tr_b16 v[142:143], v226 offset:33280
    s_waitcnt lgkmcnt(8)
    v_mfma_f32_32x32x16_bf16 v[32:47], v[120:123], v[112:115], v[32:47]
    ds_read_b64_tr_b16 v[144:145], v230 offset:32768
    ds_read_b64_tr_b16 v[146:147], v230 offset:33280
    v_mfma_f32_16x16x32_bf16 v[232:235], v[240:243], v[116:119], v[232:235]
    v_mfma_f32_16x16x32_bf16 v[236:239], v[240:243], v[120:123], v[236:239]
    s_waitcnt lgkmcnt(7)
    v_mfma_f32_32x32x16_bf16 v[16:31], v[128:131], v[124:127], v[16:31]
    ds_read_b128 v[148:151], v219 offset:32768
    ds_read_b64_tr_b16 v[152:153], v227 offset:32768
    ds_read_b64_tr_b16 v[154:155], v227 offset:33280
    ds_read_b64_tr_b16 v[156:157], v231 offset:32768
    ds_read_b64_tr_b16 v[158:159], v231 offset:33280
    s_waitcnt lgkmcnt(10)
    v_mfma_f32_32x32x16_bf16 v[32:47], v[132:135], v[124:127], v[32:47]
    s_waitcnt lgkmcnt(0)
    s_barrier
    v_mfma_f32_32x32x16_bf16 v[16:31], v[140:143], v[136:139], v[16:31]
    ds_read_b128 v[48:51], v216 offset:49152
    ds_read_b64_tr_b16 v[52:53], v224 offset:49152
    ds_read_b64_tr_b16 v[54:55], v224 offset:49664
    v_mfma_f32_32x32x16_bf16 v[32:47], v[144:147], v[136:139], v[32:47]
    ds_read_b64_tr_b16 v[56:57], v228 offset:49152
    ds_read_b64_tr_b16 v[58:59], v228 offset:49664
    v_mfma_f32_32x32x16_bf16 v[16:31], v[152:155], v[148:151], v[16:31]
    ds_read_b128 v[60:63], v217 offset:49152
    ds_read_b64_tr_b16 v[64:65], v225 offset:49152
    ds_read_b64_tr_b16 v[66:67], v225 offset:49664
    v_mfma_f32_32x32x16_bf16 v[32:47], v[156:159], v[148:151], v[32:47]
    ds_read_b64_tr_b16 v[68:69], v229 offset:49152
    ds_read_b64_tr_b16 v[70:71], v229 offset:49664
    s_waitcnt lgkmcnt(7)
    v_mfma_f32_32x32x16_bf16 v[16:31], v[52:55], v[48:51], v[16:31]
    ds_read_b128 v[72:75], v218 offset:49152
    ds_read_b64_tr_b16 v[76:77], v226 offset:49152
    ds_read_b64_tr_b16 v[78:79], v226 offset:49664
    s_waitcnt lgkmcnt(8)
    v_mfma_f32_32x32x16_bf16 v[32:47], v[56:59], v[48:51], v[32:47]
    ds_read_b64_tr_b16 v[80:81], v230 offset:49152
    ds_read_b64_tr_b16 v[82:83], v230 offset:49664
    v_mfma_f32_16x16x32_bf16 v[232:235], v[240:243], v[52:55], v[232:235]
    v_mfma_f32_16x16x32_bf16 v[236:239], v[240:243], v[56:59], v[236:239]
    s_waitcnt lgkmcnt(7)
    v_mfma_f32_32x32x16_bf16 v[16:31], v[64:67], v[60:63], v[16:31]
    ds_read_b128 v[84:87], v219 offset:49152
    ds_read_b64_tr_b16 v[88:89], v227 offset:49152
    ds_read_b64_tr_b16 v[90:91], v227 offset:49664
    ds_read_b64_tr_b16 v[92:93], v231 offset:49152
    ds_read_b64_tr_b16 v[94:95], v231 offset:49664
    s_waitcnt lgkmcnt(10)
    v_mfma_f32_32x32x16_bf16 v[32:47], v[68:71], v[60:63], v[32:47]
    s_waitcnt lgkmcnt(0)
    s_barrier
    v_mfma_f32_32x32x16_bf16 v[16:31], v[76:79], v[72:75], v[16:31]
    ds_read_b128 v[112:115], v220 offset:0
    ds_read_b64_tr_b16 v[116:117], v224 offset:0
    ds_read_b64_tr_b16 v[118:119], v224 offset:512
    v_mfma_f32_32x32x16_bf16 v[32:47], v[80:83], v[72:75], v[32:47]
    ds_read_b64_tr_b16 v[120:121], v228 offset:0
    ds_read_b64_tr_b16 v[122:123], v228 offset:512
    v_mfma_f32_32x32x16_bf16 v[16:31], v[88:91], v[84:87], v[16:31]
    ds_read_b128 v[124:127], v221 offset:0
    ds_read_b64_tr_b16 v[128:129], v225 offset:0
    ds_read_b64_tr_b16 v[130:131], v225 offset:512
    v_mfma_f32_32x32x16_bf16 v[32:47], v[92:95], v[84:87], v[32:47]
    ds_read_b64_tr_b16 v[132:133], v229 offset:0
    ds_read_b64_tr_b16 v[134:135], v229 offset:512
    s_cmp_lg_u32 s50, 0
    s_cbranch_scc1 dl_2
    buffer_load_dword v252, v253, s[44:47], 0 offen sc1
dl_2:
    s_waitcnt lgkmcnt(7)
    v_mfma_f32_32x32x16_bf16 v[16:31], v[116:119], v[112:115], v[16:31]
    ds_read_b128 v[136:139], v222 offset:0
    ds_read_b64_tr_b16 v[140:141], v226 offset:0
    ds_read_b64_tr_b16 v[142:143], v226 offset:512
    s_waitcnt lgkmcnt(8)
    v_mfma_f32_32x32x16_bf16 v[32:47], v[120:123], v[112:115], v[32:47]
    ds_read_b64_tr_b16 v[144:145], v230 offset:0
    ds_read_b64_tr_b16 v[146:147], v230 offset:512
    v_mfma_f32_16x16x32_bf16 v[232:235], v[240:243], v[116:119], v[232:235]
    v_mfma_f32_16x16x32_bf16 v[236:239], v[240:243], v[120:123], v[236:239]
    s_waitcnt lgkmcnt(7)
    v_mfma_f32_32x32x16_bf16 v[16:31], v[128:131], v[124:127], v[16:31]
    ds_read_b128 v[148:151], v223 offset:0
    ds_read_b64_tr_b16 v[152:153], v227 offset:0
    ds_read_b64_tr_b16 v[154:155], v227 offset:512
    ds_read_b64_tr_b16 v[156:157], v231 offset:0
    ds_read_b64_tr_b16 v[158:159], v231 offset:512
    s_waitcnt lgkmcnt(10)
    v_mfma_f32_32x32x16_bf16 v[32:47], v[132:135], v[124:127], v[32:47]
    s_waitcnt lgkmcnt(0)
    s_barrier
    v_mfma_f32_32x32x16_bf16 v[16:31], v[140:143], v[136:139], v[16:31]
    ds_read_b128 v[48:51], v216 offset:0
    ds_read_b64_tr_b16 v[52:53], v224 offset:16384
    ds_read_b64_tr_b16 v[54:55], v224 offset:16896
    v_mfma_f32_32x32x16_bf16 v[32:47], v[144:147], v[136:139], v[32:47]
    ds_read_b64_tr_b16 v[56:57], v228 offset:16384
    ds_read_b64_tr_b16 v[58:59], v228 offset:16896
    v_mfma_f32_32x32x16_bf16 v[16:31], v[152:155], v[148:151], v[16:31]
    ds_read_b128 v[60:63], v217 offset:0
    ds_read_b64_tr_b16 v[64:65], v225 offset:16384
    ds_read_b64_tr_b16 v[66:67], v225 offset:16896
    v_mfma_f32_32x32x16_bf16 v[32:47], v[156:159], v[148:151], v[32:47]
    ds_read_b64_tr_b16 v[68:69], v229 offset:16384
    ds_read_b64_tr_b16 v[70:71], v229 offset:16896
    s_waitcnt lgkmcnt(7)
    v_mfma_f32_32x32x16_bf16 v[16:31], v[52:55], v[48:51], v[16:31]
    ds_read_b128 v[72:75], v218 offset:0
    ds_read_b64_tr_b16 v[76:77], v226 offset:16384
    ds_read_b64_tr_b16 v[78:79], v226 offset:16896
    s_waitcnt lgkmcnt(8)
    v_mfma_f32_32x32x16_bf16 v[32:47], v[56:59], v[48:51], v[32:47]
    ds_read_b64_tr_b16 v[80:81], v230 offset:16384
    ds_read_b64_tr_b16 v[82:83], v230 offset:16896
    v_mfma_f32_16x16x32_bf16 v[232:235], v[240:243], v[52:55], v[232:235]
    v_mfma_f32_16x16x32_bf16 v[236:239], v[240:243], v[56:59], v[236:239]
    s_waitcnt lgkmcnt(7)
    v_mfma_f32_32x32x16_bf16 v[16:31], v[64:67], v[60:63], v[16:31]
    ds_read_b128 v[84:87], v219 offset:0
    ds_read_b64_tr_b16 v[88:89], v227 offset:16384
    ds_read_b64_tr_b16 v[90:91], v227 offset:16896
    ds_read_b64_tr_b16 v[92:93], v231 offset:16384
    ds_read_b64_tr_b16 v[94:95], v231 offset:16896
    s_waitcnt lgkmcnt(10)
    v_mfma_f32_32x32x16_bf16 v[32:47], v[68:71], v[60:63], v[32:47]
    s_waitcnt lgkmcnt(0)
    s_barrier
    v_mfma_f32_32x32x16_bf16 v[16:31], v[76:79], v[72:75], v[16:31]
    ds_read_b128 v[112:115], v216 offset:16384
    ds_read_b64_tr_b16 v[116:117], v224 offset:32768
    ds_read_b64_tr_b16 v[118:119], v224 offset:33280
    v_mfma_f32_32x32x16_bf16 v[32:47], v[80:83], v[72:75], v[32:47]
    ds_read_b64_tr_b16 v[120:121], v228 offset:32768
    ds_read_b64_tr_b16 v[122:123], v228 offset:33280
    v_mfma_f32_32x32x16_bf16 v[16:31], v[88:91], v[84:87], v[16:31]
    ds_read_b128 v[124:127], v217 offset:16384
    ds_read_b64_tr_b16 v[128:129], v225 offset:32768
    ds_read_b64_tr_b16 v[130:131], v225 offset:33280
    v_mfma_f32_32x32x16_bf16 v[32:47], v[92:95], v[84:87], v[32:47]
    ds_read_b64_tr_b16 v[132:133], v229 offset:32768
    ds_read_b64_tr_b16 v[134:135], v229 offset:33280
    s_waitcnt lgkmcnt(7)
    v_mfma_f32_32x32x16_bf16 v[16:31], v[116:119], v[112:115], v[16:31]
    ds_read_b128 v[136:139], v218 offset:16384
    ds_read_b64_tr_b16 v[140:141], v226 offset:32768
    ds_read_b64_tr_b16 v[142:143], v226 offset:33280
    s_waitcnt lgkmcnt(8)
    v_mfma_f32_32x32x16_bf16 v[32:47], v[120:123], v[112:115], v[32:47]
    ds_read_b64_tr_b16 v[144:145], v230 offset:32768
    ds_read_b64_tr_b16 v[146:147], v230 offset:33280
    v_mfma_f32_16x16x32_bf16 v[232:235], v[240:243], v[116:119], v[232:235]
    v_mfma_f32_16x16x32_bf16 v[236:239], v[240:243], v[120:123], v[236:239]
    s_waitcnt lgkmcnt(7)
    v_mfma_f32_32x32x16_bf16 v[16:31], v[128:131], v[124:127], v[16:31]
    ds_read_b128 v[148:151], v219 offset:16384
    ds_read_b64_tr_b16 v[152:153], v227 offset:32768
    ds_read_b64_tr_b16 v[154:155], v227 offset:33280
    s_waitcnt lgkmcnt(8)
    v_mfma_f32_32x32x16_bf16 v[32:47], v[132:135], v[124:127], v[32:47]
    ds_read_b64_tr_b16 v[156:157], v231 offset:32768
    ds_read_b64_tr_b16 v[158:159], v231 offset:33280
    s_mov_b32 exec_hi, 0
    ds_write_b32 v248, v232 offset:0
    ds_write_b32 v248, v236 offset:128
    s_mov_b32 exec_hi, -1
    s_waitcnt lgkmcnt(9)
    v_mfma_f32_32x32x16_bf16 v[16:31], v[140:143], v[136:139], v[16:31]
    s_waitcnt lgkmcnt(7)
    v_mfma_f32_32x32x16_bf16 v[32:47], v[144:147], v[136:139], v[32:47]
    s_waitcnt lgkmcnt(4)
    v_mfma_f32_32x32x16_bf16 v[16:31], v[152:155], v[148:151], v[16:31]
    s_waitcnt lgkmcnt(2)
    v_mfma_f32_32x32x16_bf16 v[32:47], v[156:159], v[148:151], v[32:47]
    s_cmp_lg_u32 s50, 0
    s_cbranch_scc1 dbg_3
    s_waitcnt vmcnt(0)
    v_cmp_ne_u32 vcc, 1, v252
    s_nop 4
    s_cbranch_vccz dbg_3
    s_mov_b32 s96, 0
pl_4:
    buffer_load_dword v252, v253, s[44:47], 0 offen sc1
    s_add_u32 s96, s96, 1
    s_waitcnt vmcnt(0)
    v_cmp_ne_u32 vcc, 1, v252
    s_cmp_ge_u32 s96, 20000
    s_cbranch_scc1 pl_4_ok
    s_nop 2
    s_cbranch_vccz pl_4_ok
    s_sleep 2
    s_branch pl_4
pl_4_ok:
dbg_3:
    s_waitcnt lgkmcnt(0)
    s_barrier
    s_setprio 3
    s_cmp_ge_u32 s49, 14
    s_cbranch_scc1 fz_a2
    ds_read_b32 v244, v174 offset:2816
    ds_read2_b32 v[232:233], v250 offset0:0 offset1:128
    ds_read2_b32 v[236:237], v250 offset0:32 offset1:160
    ds_read_b32 v246, v174
    s_waitcnt lgkmcnt(2)
    v_add_f32 v232, v232, v233
    s_nop 1
    v_mfma_f32_32x32x2_f32 v[16:31], v232, v244, v[16:31]
    s_waitcnt lgkmcnt(1)
    v_add_f32 v236, v236, v237
    s_nop 1
    v_mfma_f32_32x32x2_f32 v[32:47], v236, v244, v[32:47]
    s_waitcnt lgkmcnt(0)
    s_nop 13
    v_mul_f32 v16, v16, v246
    v_mul_f32 v17, v17, v246
    v_mul_f32 v18, v18, v246
    v_mul_f32 v19, v19, v246
    v_mul_f32 v20, v20, v246
    v_mul_f32 v21, v21, v246
    v_mul_f32 v22, v22, v246
    v_mul_f32 v23, v23, v246
    v_mul_f32 v24, v24, v246
    v_mul_f32 v25, v25, v246
    v_mul_f32 v26, v26, v246
    v_mul_f32 v27, v27, v246
    v_mul_f32 v28, v28, v246
    v_mul_f32 v29, v29, v246
    v_mul_f32 v30, v30, v246
    v_mul_f32 v31, v31, v246
    v_cvt_pk_bf16_f32 v16, v16, v17
    v_cvt_pk_bf16_f32 v17, v18, v19
    v_cvt_pk_bf16_f32 v18, v20, v21
    v_cvt_pk_bf16_f32 v19, v22, v23
    v_cvt_pk_bf16_f32 v20, v24, v25
    v_cvt_pk_bf16_f32 v21, v26, v27
    v_cvt_pk_bf16_f32 v22, v28, v29
    v_cvt_pk_bf16_f32 v23, v30, v31
    v_permlane32_swap_b32 v16, v18
    v_permlane32_swap_b32 v17, v19
    v_permlane32_swap_b32 v20, v22
    v_permlane32_swap_b32 v21, v23
    buffer_store_dwordx4 v[16:19], v15, s[40:43], s70 offen offset:0 sc1
    buffer_store_dwordx4 v[20:23], v15, s[40:43], s70 offen offset:1024 sc1
    v_mul_f32 v32, v32, v246
    v_mul_f32 v33, v33, v246
    v_mul_f32 v34, v34, v246
    v_mul_f32 v35, v35, v246
    v_mul_f32 v36, v36, v246
    v_mul_f32 v37, v37, v246
    v_mul_f32 v38, v38, v246
    v_mul_f32 v39, v39, v246
    v_mul_f32 v40, v40, v246
    v_mul_f32 v41, v41, v246
    v_mul_f32 v42, v42, v246
    v_mul_f32 v43, v43, v246
    v_mul_f32 v44, v44, v246
    v_mul_f32 v45, v45, v246
    v_mul_f32 v46, v46, v246
    v_mul_f32 v47, v47, v246
    v_cvt_pk_bf16_f32 v32, v32, v33
    v_cvt_pk_bf16_f32 v33, v34, v35
    v_cvt_pk_bf16_f32 v34, v36, v37
    v_cvt_pk_bf16_f32 v35, v38, v39
    v_cvt_pk_bf16_f32 v36, v40, v41
    v_cvt_pk_bf16_f32 v37, v42, v43
    v_cvt_pk_bf16_f32 v38, v44, v45
    v_cvt_pk_bf16_f32 v39, v46, v47
    v_permlane32_swap_b32 v32, v34
    v_permlane32_swap_b32 v33, v35
    v_permlane32_swap_b32 v36, v38
    v_permlane32_swap_b32 v37, v39
    buffer_store_dwordx4 v[32:35], v15, s[40:43], s70 offen offset:2048 sc1
    buffer_store_dwordx4 v[36:39], v15, s[40:43], s70 offen offset:3072 sc1
    s_branch fz_a2
fz_av:
    s_waitcnt vmcnt(8) lgkmcnt(0)
    s_barrier
    ds_read_b128 v[112:115], v216 offset:0
    ds_read_b64_tr_b16 v[116:117], v224 offset:0
    ds_read_b64_tr_b16 v[118:119], v224 offset:512
    ds_read_b64_tr_b16 v[120:121], v228 offset:0
    ds_read_b64_tr_b16 v[122:123], v228 offset:512
    ds_read_b128 v[124:127], v217 offset:0
    ds_read_b64_tr_b16 v[128:129], v225 offset:0
    ds_read_b64_tr_b16 v[130:131], v225 offset:512
    ds_read_b64_tr_b16 v[132:133], v229 offset:0
    ds_read_b64_tr_b16 v[134:135], v229 offset:512
    ds_read_b128 v[136:139], v218 offset:0
    ds_read_b64_tr_b16 v[140:141], v226 offset:0
    ds_read_b64_tr_b16 v[142:143], v226 offset:512
    ds_read_b64_tr_b16 v[144:145], v230 offset:0
    ds_read_b64_tr_b16 v[146:147], v230 offset:512
    ds_read_b128 v[148:151], v219 offset:0
    ds_read_b64_tr_b16 v[152:153], v227 offset:0
    ds_read_b64_tr_b16 v[154:155], v227 offset:512
    ds_read_b64_tr_b16 v[156:157], v231 offset:0
    ds_read_b64_tr_b16 v[158:159], v231 offset:512
    s_waitcnt lgkmcnt(15)
    v_mfma_f32_32x32x16_bf16 v[16:31], v[112:115], v[116:119], 0
    s_waitcnt lgkmcnt(15)
    v_mfma_f32_32x32x16_bf16 v[32:47], v[112:115], v[120:123], 0
    v_mfma_f32_16x16x32_bf16 v[232:235], v[240:243], v[116:119], 0
    v_mfma_f32_16x16x32_bf16 v[236:239], v[240:243], v[120:123], 0
    s_waitcnt lgkmcnt(12)
    v_mfma_f32_32x32x16_bf16 v[16:31], v[124:127], v[128:131], v[16:31]
    s_waitcnt lgkmcnt(10)
    v_mfma_f32_32x32x16_bf16 v[32:47], v[124:127], v[132:135], v[32:47]
    s_waitcnt vmcnt(4) lgkmcnt(0)
    s_barrier
    v_mfma_f32_32x32x16_bf16 v[16:31], v[136:139], v[140:143], v[16:31]
    ds_read_b128 v[48:51], v216 offset:16384
    ds_read_b64_tr_b16 v[52:53], v224 offset:16384
    ds_read_b64_tr_b16 v[54:55], v224 offset:16896
    v_mfma_f32_32x32x16_bf16 v[32:47], v[136:139], v[144:147], v[32:47]
    ds_read_b64_tr_b16 v[56:57], v228 offset:16384
    ds_read_b64_tr_b16 v[58:59], v228 offset:16896
    v_mfma_f32_32x32x16_bf16 v[16:31], v[148:151], v[152:155], v[16:31]
    ds_read_b128 v[60:63], v217 offset:16384
    ds_read_b64_tr_b16 v[64:65], v225 offset:16384
    ds_read_b64_tr_b16 v[66:67], v225 offset:16896
    v_mfma_f32_32x32x16_bf16 v[32:47], v[148:151], v[156:159], v[32:47]
    ds_read_b64_tr_b16 v[68:69], v229 offset:16384
    ds_read_b64_tr_b16 v[70:71], v229 offset:16896
    s_waitcnt lgkmcnt(7)
    v_mfma_f32_32x32x16_bf16 v[16:31], v[48:51], v[52:55], v[16:31]
    ds_read_b128 v[72:75], v218 offset:16384
    ds_read_b64_tr_b16 v[76:77], v226 offset:16384
    ds_read_b64_tr_b16 v[78:79], v226 offset:16896
    s_waitcnt lgkmcnt(8)
    v_mfma_f32_32x32x16_bf16 v[32:47], v[48:51], v[56:59], v[32:47]
    ds_read_b64_tr_b16 v[80:81], v230 offset:16384
    ds_read_b64_tr_b16 v[82:83], v230 offset:16896
    v_mfma_f32_16x16x32_bf16 v[232:235], v[240:243], v[52:55], v[232:235]
    v_mfma_f32_16x16x32_bf16 v[236:239], v[240:243], v[56:59], v[236:239]
    s_waitcnt lgkmcnt(7)
    v_mfma_f32_32x32x16_bf16 v[16:31], v[60:63], v[64:67], v[16:31]
    ds_read_b128 v[84:87], v219 offset:16384
    ds_read_b64_tr_b16 v[88:89], v227 offset:16384
    ds_read_b64_tr_b16 v[90:91], v227 offset:16896
    ds_read_b64_tr_b16 v[92:93], v231 offset:16384
    ds_read_b64_tr_b16 v[94:95], v231 offset:16896
    s_waitcnt lgkmcnt(10)
    v_mfma_f32_32x32x16_bf16 v[32:47], v[60:63], v[68:71], v[32:47]
    s_waitcnt vmcnt(0) lgkmcnt(0)
    s_barrier
    v_mfma_f32_32x32x16_bf16 v[16:31], v[72:75], v[76:79], v[16:31]
    ds_read_b128 v[112:115], v216 offset:32768
    ds_read_b64_tr_b16 v[116:117], v224 offset:32768
    ds_read_b64_tr_b16 v[118:119], v224 offset:33280
    v_mfma_f32_32x32x16_bf16 v[32:47], v[72:75], v[80:83], v[32:47]
    ds_read_b64_tr_b16 v[120:121], v228 offset:32768
    ds_read_b64_tr_b16 v[122:123], v228 offset:33280
    v_mfma_f32_32x32x16_bf16 v[16:31], v[84:87], v[88:91], v[16:31]
    ds_read_b128 v[124:127], v217 offset:32768
    ds_read_b64_tr_b16 v[128:129], v225 offset:32768
    ds_read_b64_tr_b16 v[130:131], v225 offset:33280
    v_mfma_f32_32x32x16_bf16 v[32:47], v[84:87], v[92:95], v[32:47]
    ds_read_b64_tr_b16 v[132:133], v229 offset:32768
    ds_read_b64_tr_b16 v[134:135], v229 offset:33280
    s_waitcnt lgkmcnt(7)
    v_mfma_f32_32x32x16_bf16 v[16:31], v[112:115], v[116:119], v[16:31]
    ds_read_b128 v[136:139], v218 offset:32768
    ds_read_b64_tr_b16 v[140:141], v226 offset:32768
    ds_read_b64_tr_b16 v[142:143], v226 offset:33280
    s_waitcnt lgkmcnt(8)
    v_mfma_f32_32x32x16_bf16 v[32:47], v[112:115], v[120:123], v[32:47]
    ds_read_b64_tr_b16 v[144:145], v230 offset:32768
    ds_read_b64_tr_b16 v[146:147], v230 offset:33280
    v_mfma_f32_16x16x32_bf16 v[232:235], v[240:243], v[116:119], v[232:235]
    v_mfma_f32_16x16x32_bf16 v[236:239], v[240:243], v[120:123], v[236:239]
    s_waitcnt lgkmcnt(7)
    v_mfma_f32_32x32x16_bf16 v[16:31], v[124:127], v[128:131], v[16:31]
    ds_read_b128 v[148:151], v219 offset:32768
    ds_read_b64_tr_b16 v[152:153], v227 offset:32768
    ds_read_b64_tr_b16 v[154:155], v227 offset:33280
    ds_read_b64_tr_b16 v[156:157], v231 offset:32768
    ds_read_b64_tr_b16 v[158:159], v231 offset:33280
    s_waitcnt lgkmcnt(10)
    v_mfma_f32_32x32x16_bf16 v[32:47], v[124:127], v[132:135], v[32:47]
    s_waitcnt lgkmcnt(0)
    s_barrier
    v_mfma_f32_32x32x16_bf16 v[16:31], v[136:139], v[140:143], v[16:31]
    ds_read_b128 v[48:51], v216 offset:49152
    ds_read_b64_tr_b16 v[52:53], v224 offset:49152
    ds_read_b64_tr_b16 v[54:55], v224 offset:49664
    v_mfma_f32_32x32x16_bf16 v[32:47], v[136:139], v[144:147], v[32:47]
    ds_read_b64_tr_b16 v[56:57], v228 offset:49152
    ds_read_b64_tr_b16 v[58:59], v228 offset:49664
    v_mfma_f32_32x32x16_bf16 v[16:31], v[148:151], v[152:155], v[16:31]
    ds_read_b128 v[60:63], v217 offset:49152
    ds_read_b64_tr_b16 v[64:65], v225 offset:49152
    ds_read_b64_tr_b16 v[66:67], v225 offset:49664
    v_mfma_f32_32x32x16_bf16 v[32:47], v[148:151], v[156:159], v[32:47]
    ds_read_b64_tr_b16 v[68:69], v229 offset:49152
    ds_read_b64_tr_b16 v[70:71], v229 offset:49664
    s_waitcnt lgkmcnt(7)
    v_mfma_f32_32x32x16_bf16 v[16:31], v[48:51], v[52:55], v[16:31]
    ds_read_b128 v[72:75], v218 offset:49152
    ds_read_b64_tr_b16 v[76:77], v226 offset:49152
    ds_read_b64_tr_b16 v[78:79], v226 offset:49664
    s_waitcnt lgkmcnt(8)
    v_mfma_f32_32x32x16_bf16 v[32:47], v[48:51], v[56:59], v[32:47]
    ds_read_b64_tr_b16 v[80:81], v230 offset:49152
    ds_read_b64_tr_b16 v[82:83], v230 offset:49664
    v_mfma_f32_16x16x32_bf16 v[232:235], v[240:243], v[52:55], v[232:235]
    v_mfma_f32_16x16x32_bf16 v[236:239], v[240:243], v[56:59], v[236:239]
    s_waitcnt lgkmcnt(7)
    v_mfma_f32_32x32x16_bf16 v[16:31], v[60:63], v[64:67], v[16:31]
    ds_read_b128 v[84:87], v219 offset:49152
    ds_read_b64_tr_b16 v[88:89], v227 offset:49152
    ds_read_b64_tr_b16 v[90:91], v227 offset:49664
    ds_read_b64_tr_b16 v[92:93], v231 offset:49152
    ds_read_b64_tr_b16 v[94:95], v231 offset:49664
    s_waitcnt lgkmcnt(10)
    v_mfma_f32_32x32x16_bf16 v[32:47], v[60:63], v[68:71], v[32:47]
    s_waitcnt lgkmcnt(0)
    s_barrier
    v_mfma_f32_32x32x16_bf16 v[16:31], v[72:75], v[76:79], v[16:31]
    ds_read_b128 v[112:115], v220 offset:0
    ds_read_b64_tr_b16 v[116:117], v224 offset:0
    ds_read_b64_tr_b16 v[118:119], v224 offset:512
    v_mfma_f32_32x32x16_bf16 v[32:47], v[72:75], v[80:83], v[32:47]
    ds_read_b64_tr_b16 v[120:121], v228 offset:0
    ds_read_b64_tr_b16 v[122:123], v228 offset:512
    v_mfma_f32_32x32x16_bf16 v[16:31], v[84:87], v[88:91], v[16:31]
    ds_read_b128 v[124:127], v221 offset:0
    ds_read_b64_tr_b16 v[128:129], v225 offset:0
    ds_read_b64_tr_b16 v[130:131], v225 offset:512
    v_mfma_f32_32x32x16_bf16 v[32:47], v[84:87], v[92:95], v[32:47]
    ds_read_b64_tr_b16 v[132:133], v229 offset:0
    ds_read_b64_tr_b16 v[134:135], v229 offset:512
    s_cmp_lg_u32 s50, 0
    s_cbranch_scc1 dl_5
    buffer_load_dword v252, v253, s[44:47], 0 offen sc1
dl_5:
    s_waitcnt lgkmcnt(7)
    v_mfma_f32_32x32x16_bf16 v[16:31], v[112:115], v[116:119], v[16:31]
    ds_read_b128 v[136:139], v222 offset:0
    ds_read_b64_tr_b16 v[140:141], v226 offset:0
    ds_read_b64_tr_b16 v[142:143], v226 offset:512
    s_waitcnt lgkmcnt(8)
    v_mfma_f32_32x32x16_bf16 v[32:47], v[112:115], v[120:123], v[32:47]
    ds_read_b64_tr_b16 v[144:145], v230 offset:0
    ds_read_b64_tr_b16 v[146:147], v230 offset:512
    v_mfma_f32_16x16x32_bf16 v[232:235], v[240:243], v[116:119], v[232:235]
    v_mfma_f32_16x16x32_bf16 v[236:239], v[240:243], v[120:123], v[236:239]
    s_waitcnt lgkmcnt(7)
    v_mfma_f32_32x32x16_bf16 v[16:31], v[124:127], v[128:131], v[16:31]
    ds_read_b128 v[148:151], v223 offset:0
    ds_read_b64_tr_b16 v[152:153], v227 offset:0
    ds_read_b64_tr_b16 v[154:155], v227 offset:512
    ds_read_b64_tr_b16 v[156:157], v231 offset:0
    ds_read_b64_tr_b16 v[158:159], v231 offset:512
    s_waitcnt lgkmcnt(10)
    v_mfma_f32_32x32x16_bf16 v[32:47], v[124:127], v[132:135], v[32:47]
    s_waitcnt lgkmcnt(0)
    s_barrier
    v_mfma_f32_32x32x16_bf16 v[16:31], v[136:139], v[140:143], v[16:31]
    ds_read_b128 v[48:51], v216 offset:0
    ds_read_b64_tr_b16 v[52:53], v224 offset:16384
    ds_read_b64_tr_b16 v[54:55], v224 offset:16896
    v_mfma_f32_32x32x16_bf16 v[32:47], v[136:139], v[144:147], v[32:47]
    ds_read_b64_tr_b16 v[56:57], v228 offset:16384
    ds_read_b64_tr_b16 v[58:59], v228 offset:16896
    v_mfma_f32_32x32x16_bf16 v[16:31], v[148:151], v[152:155], v[16:31]
    ds_read_b128 v[60:63], v217 offset:0
    ds_read_b64_tr_b16 v[64:65], v225 offset:16384
    ds_read_b64_tr_b16 v[66:67], v225 offset:16896
    v_mfma_f32_32x32x16_bf16 v[32:47], v[148:151], v[156:159], v[32:47]
    ds_read_b64_tr_b16 v[68:69], v229 offset:16384
    ds_read_b64_tr_b16 v[70:71], v229 offset:16896
    s_waitcnt lgkmcnt(7)
    v_mfma_f32_32x32x16_bf16 v[16:31], v[48:51], v[52:55], v[16:31]
    ds_read_b128 v[72:75], v218 offset:0
    ds_read_b64_tr_b16 v[76:77], v226 offset:16384
    ds_read_b64_tr_b16 v[78:79], v226 offset:16896
    s_waitcnt lgkmcnt(8)
    v_mfma_f32_32x32x16_bf16 v[32:47], v[48:51], v[56:59], v[32:47]
    ds_read_b64_tr_b16 v[80:81], v230 offset:16384
    ds_read_b64_tr_b16 v[82:83], v230 offset:16896
    v_mfma_f32_16x16x32_bf16 v[232:235], v[240:243], v[52:55], v[232:235]
    v_mfma_f32_16x16x32_bf16 v[236:239], v[240:243], v[56:59], v[236:239]
    s_waitcnt lgkmcnt(7)
    v_mfma_f32_32x32x16_bf16 v[16:31], v[60:63], v[64:67], v[16:31]
    ds_read_b128 v[84:87], v219 offset:0
    ds_read_b64_tr_b16 v[88:89], v227 offset:16384
    ds_read_b64_tr_b16 v[90:91], v227 offset:16896
    ds_read_b64_tr_b16 v[92:93], v231 offset:16384
    ds_read_b64_tr_b16 v[94:95], v231 offset:16896
    s_waitcnt lgkmcnt(10)
    v_mfma_f32_32x32x16_bf16 v[32:47], v[60:63], v[68:71], v[32:47]
    s_waitcnt lgkmcnt(0)
    s_barrier
    v_mfma_f32_32x32x16_bf16 v[16:31], v[72:75], v[76:79], v[16:31]
    ds_read_b128 v[112:115], v216 offset:16384
    ds_read_b64_tr_b16 v[116:117], v224 offset:32768
    ds_read_b64_tr_b16 v[118:119], v224 offset:33280
    v_mfma_f32_32x32x16_bf16 v[32:47], v[72:75], v[80:83], v[32:47]
    ds_read_b64_tr_b16 v[120:121], v228 offset:32768
    ds_read_b64_tr_b16 v[122:123], v228 offset:33280
    v_mfma_f32_32x32x16_bf16 v[16:31], v[84:87], v[88:91], v[16:31]
    ds_read_b128 v[124:127], v217 offset:16384
    ds_read_b64_tr_b16 v[128:129], v225 offset:32768
    ds_read_b64_tr_b16 v[130:131], v225 offset:33280
    v_mfma_f32_32x32x16_bf16 v[32:47], v[84:87], v[92:95], v[32:47]
    ds_read_b64_tr_b16 v[132:133], v229 offset:32768
    ds_read_b64_tr_b16 v[134:135], v229 offset:33280
    s_waitcnt lgkmcnt(7)
    v_mfma_f32_32x32x16_bf16 v[16:31], v[112:115], v[116:119], v[16:31]
    ds_read_b128 v[136:139], v218 offset:16384
    ds_read_b64_tr_b16 v[140:141], v226 offset:32768
    ds_read_b64_tr_b16 v[142:143], v226 offset:33280
    s_waitcnt lgkmcnt(8)
    v_mfma_f32_32x32x16_bf16 v[32:47], v[112:115], v[120:123], v[32:47]
    ds_read_b64_tr_b16 v[144:145], v230 offset:32768
    ds_read_b64_tr_b16 v[146:147], v230 offset:33280
    v_mfma_f32_16x16x32_bf16 v[232:235], v[240:243], v[116:119], v[232:235]
    v_mfma_f32_16x16x32_bf16 v[236:239], v[240:243], v[120:123], v[236:239]
    s_waitcnt lgkmcnt(7)
    v_mfma_f32_32x32x16_bf16 v[16:31], v[124:127], v[128:131], v[16:31]
    ds_read_b128 v[148:151], v219 offset:16384
    ds_read_b64_tr_b16 v[152:153], v227 offset:32768
    ds_read_b64_tr_b16 v[154:155], v227 offset:33280
    s_waitcnt lgkmcnt(8)
    v_mfma_f32_32x32x16_bf16 v[32:47], v[124:127], v[132:135], v[32:47]
    ds_read_b64_tr_b16 v[156:157], v231 offset:32768
    ds_read_b64_tr_b16 v[158:159], v231 offset:33280
    s_mov_b32 exec_hi, 0
    ds_write_b32 v248, v232 offset:0
    ds_write_b32 v248, v236 offset:128
    s_mov_b32 exec_hi, -1
    s_waitcnt lgkmcnt(9)
    v_mfma_f32_32x32x16_bf16 v[16:31], v[136:139], v[140:143], v[16:31]
    s_waitcnt lgkmcnt(7)
    v_mfma_f32_32x32x16_bf16 v[32:47], v[136:139], v[144:147], v[32:47]
    s_waitcnt lgkmcnt(4)
    v_mfma_f32_32x32x16_bf16 v[16:31], v[148:151], v[152:155], v[16:31]
    s_waitcnt lgkmcnt(2)
    v_mfma_f32_32x32x16_bf16 v[32:47], v[148:151], v[156:159], v[32:47]
    s_cmp_lg_u32 s50, 0
    s_cbranch_scc1 dbg_6
    s_waitcnt vmcnt(0)
    v_cmp_ne_u32 vcc, 1, v252
    s_nop 4
    s_cbranch_vccz dbg_6
    s_mov_b32 s96, 0
pl_7:
    buffer_load_dword v252, v253, s[44:47], 0 offen sc1
    s_add_u32 s96, s96, 1
    s_waitcnt vmcnt(0)
    v_cmp_ne_u32 vcc, 1, v252
    s_cmp_ge_u32 s96, 20000
    s_cbranch_scc1 pl_7_ok
    s_nop 2
    s_cbranch_vccz pl_7_ok
    s_sleep 2
    s_branch pl_7
pl_7_ok:
dbg_6:
    s_waitcnt lgkmcnt(0)
    s_barrier
    s_setprio 3
    ds_read_b32 v244, v174 offset:2816
    ds_read2_b32 v[232:233], v250 offset0:0 offset1:128
    ds_read2_b32 v[236:237], v250 offset0:32 offset1:160
    ds_read_b128 v[112:115], v249 offset:0
    ds_read_b128 v[116:119], v249 offset:32
    ds_read_b128 v[120:123], v249 offset:64
    ds_read_b128 v[124:127], v249 offset:96
    s_waitcnt lgkmcnt(5)
    v_add_f32 v232, v232, v233
    s_nop 1
    v_mfma_f32_32x32x2_f32 v[16:31], v244, v232, v[16:31]
    s_waitcnt lgkmcnt(4)
    v_add_f32 v236, v236, v237
    s_nop 1
    v_mfma_f32_32x32x2_f32 v[32:47], v244, v236, v[32:47]
    s_waitcnt lgkmcnt(0)
    s_nop 13
    v_mul_f32 v16, v16, v112
    v_mul_f32 v17, v17, v113
    v_mul_f32 v18, v18, v114
    v_mul_f32 v19, v19, v115
    v_mul_f32 v20, v20, v116
    v_mul_f32 v21, v21, v117
    v_mul_f32 v22, v22, v118
    v_mul_f32 v23, v23, v119
    v_mul_f32 v24, v24, v120
    v_mul_f32 v25, v25, v121
    v_mul_f32 v26, v26, v122
    v_mul_f32 v27, v27, v123
    v_mul_f32 v28, v28, v124
    v_mul_f32 v29, v29, v125
    v_mul_f32 v30, v30, v126
    v_mul_f32 v31, v31, v127
    v_cvt_pk_bf16_f32 v16, v16, v17
    v_cvt_pk_bf16_f32 v17, v18, v19
    v_cvt_pk_bf16_f32 v18, v20, v21
    v_cvt_pk_bf16_f32 v19, v22, v23
    v_cvt_pk_bf16_f32 v20, v24, v25
    v_cvt_pk_bf16_f32 v21, v26, v27
    v_cvt_pk_bf16_f32 v22, v28, v29
    v_cvt_pk_bf16_f32 v23, v30, v31
    buffer_store_dwordx4 v[16:19], v251, s[40:43], s70 offen offset:0 sc1
    buffer_store_dwordx4 v[20:23], v251, s[40:43], s71 offen offset:0 sc1
    v_mul_f32 v32, v32, v112
    v_mul_f32 v33, v33, v113
    v_mul_f32 v34, v34, v114
    v_mul_f32 v35, v35, v115
    v_mul_f32 v36, v36, v116
    v_mul_f32 v37, v37, v117
    v_mul_f32 v38, v38, v118
    v_mul_f32 v39, v39, v119
    v_mul_f32 v40, v40, v120
    v_mul_f32 v41, v41, v121
    v_mul_f32 v42, v42, v122
    v_mul_f32 v43, v43, v123
    v_mul_f32 v44, v44, v124
    v_mul_f32 v45, v45, v125
    v_mul_f32 v46, v46, v126
    v_mul_f32 v47, v47, v127
    v_cvt_pk_bf16_f32 v32, v32, v33
    v_cvt_pk_bf16_f32 v33, v34, v35
    v_cvt_pk_bf16_f32 v34, v36, v37
    v_cvt_pk_bf16_f32 v35, v38, v39
    v_cvt_pk_bf16_f32 v36, v40, v41
    v_cvt_pk_bf16_f32 v37, v42, v43
    v_cvt_pk_bf16_f32 v38, v44, v45
    v_cvt_pk_bf16_f32 v39, v46, v47
    buffer_store_dwordx4 v[32:35], v251, s[40:43], s70 offen offset:512 sc1
    buffer_store_dwordx4 v[36:39], v251, s[40:43], s71 offen offset:512 sc1
fz_a2:
    s_mul_i32 s72, s49, 7
    s_lshr_b32 s72, s72, 1
    s_lshl_b32 s73, s72, 9
    v_add_u32 v7, s73, v15
    s_mul_i32 s73, s49, 28
    s_lshl_b32 s74, s73, 4
    v_add_u32 v8, s74, v251
    v_add_u32 v9, 14336, v8
    s_mov_b32 s66, 0x0fffffff
    s_mov_b32 s67, 0x0fffffff
    s_bfe_u32 s74, s72, 0x10003
    s_lshl_b32 s68, 1, s74
    s_add_u32 s72, s72, 3
    s_bfe_u32 s72, s72, 0x10003
    s_bitset1_b32 s68, s72
    s_bfe_u32 s74, s73, 0x10006
    s_add_u32 s74, s74, 2
    s_bitset1_b32 s68, s74
    s_add_u32 s73, s73, 27
    s_bfe_u32 s73, s73, 0x10006
    s_add_u32 s73, s73, 2
    s_bitset1_b32 s68, s73
    s_mul_i32 s68, s68, 0x11111111
    s_mov_b32 s69, s68
    s_mul_i32 s72, s50, 917504
    s_add_u32 s24, s22, s72
    s_addc_u32 s25, s23, 0
    s_mov_b32 s26, 917504
    s_mov_b32 s27, 0x20000
    s_add_u32 s28, s22, 0
    s_addc_u32 s29, s23, 0
    s_mov_b32 s30, 3670016
    s_mov_b32 s31, 0x20000
    s_add_u32 s72, s59, s50
    s_lshl_b32 s72, s72, 7
    s_add_u32 s72, s72, 16777216
    s_sub_u32 s77, s49, 7
    s_cselect_b32 s77, s49, s77
    s_cselect_b32 s78, 0, 2
    s_and_b32 s73, s77, 1
    s_add_u32 s78, s78, s73
    s_and_b32 s73, s48, 3
    s_lshl_b32 s73, s73, 2
    s_add_u32 s78, s78, s73
    s_lshl_b32 s78, s78, 2
    s_lshr_b32 s73, s48, 2
    s_lshl_b32 s73, s73, 7
    s_add_u32 s73, s73, s78
    s_add_u32 s73, s73, 16777216
    s_mul_i32 s77, s77, 37
    s_lshr_b32 s77, s77, 4
    v_lshrrev_b32 v228, 4, v1
    v_add_u32 v228, s77, v228
    v_min_u32 v228, 15, v228
    v_lshlrev_b32 v228, 9, v228
    v_and_b32 v220, 15, v1
    v_lshl_add_u32 v228, v220, 13, v228
    v_lshlrev_b32 v220, 2, v220
    s_lshl_b32 s74, s50, 11
    s_add_u32 s74, s74, 147456
    v_add_u32 v221, s74, v15
    v_xor_b32 v222, 2048, v221
    v_xor_b32 v223, 4096, v221
    v_xor_b32 v224, 6144, v221
    v_mov_b32 v148, 0
    v_mov_b32 v149, 0
    v_mov_b32 v150, 0
    v_mov_b32 v151, 0
    v_mov_b32 v142, 0
    v_mov_b32 v143, 0
    s_mul_i32 s75, s49, 7
    s_lshr_b32 s75, s75, 1
    s_lshl_b32 s75, s75, 9
    s_mul_i32 s76, s49, 448
    s_add_u32 s76, s76, 28672
    v_and_b32 v225, 15, v1
    v_lshlrev_b32 v226, 7, v225
    v_add_u32 v226, s75, v226
    v_lshrrev_b32 v227, 2, v225
    v_mul_u32_u24 v227, 7168, v227
    v_and_b32 v225, 3, v1
    v_lshl_add_u32 v227, v225, 7, v227
    v_add_u32 v227, s76, v227
    v_cndmask_b32 v226, v226, v227, s[56:57]
    v_bfe_u32 v225, v1, 4, 1
    v_mul_u32_u24 v225, 57344, v225
    v_add_u32 v226, v226, v225
    s_and_b32 s75, s48, 7
    s_mul_i32 s75, s75, 114688
    s_cmp_ge_u32 s49, 14
    s_cbranch_scc1 fz_a3
    s_waitcnt vmcnt(0)
    ds_add_rtn_u32 v216, v2, v3 offset:0
    v_mov_b32 v217, v228
    s_waitcnt lgkmcnt(0)
    v_readfirstlane_b32 s97, v216
    s_nop 1
    s_cmp_lg_u32 s97, 3
    s_cbranch_scc1 fa_8
    buffer_store_dword v3, v217, s[40:43], s73 offen sc1
fa_8:
fz_a3:
    s_mov_b32 s96, 0
sw_10:
    ds_read_b32 v216, v6 offset:8
    s_add_u32 s96, s96, 1
    s_waitcnt lgkmcnt(0)
    v_readfirstlane_b32 s97, v216
    s_nop 1
    s_cmp_ge_u32 s97, 4
    s_cbranch_scc1 ok_9
    s_cmp_ge_u32 s96, 160000
    s_cbranch_scc1 ok_9
    s_sleep 1
    s_branch sw_10
ok_9:
    ds_read_b128 v[16:19], v221 offset:0
    ds_read_b128 v[20:23], v221 offset:1024
    ds_read_b128 v[24:27], v222 offset:0
    ds_read_b128 v[28:31], v222 offset:1024
    ds_read_b128 v[32:35], v223 offset:0
    ds_read_b128 v[36:39], v223 offset:1024
    ds_read_b128 v[40:43], v224 offset:0
    ds_read_b128 v[44:47], v224 offset:1024
    ds_add_u32 v2, v3 offset:12
    v_and_b32 v216, 31, v1
    v_cmp_eq_u32 vcc, 28, v216
    v_mov_b32 v216, s55
    s_nop 0
    v_cndmask_b32 v216, 0, v216, vcc
    v_mov_b32 v48, 0
    v_mov_b32 v49, 0
    v_mov_b32 v50, 0
    v_mov_b32 v51, 0
    v_mov_b32 v52, 0
    v_mov_b32 v53, 0
    v_mov_b32 v54, 0
    v_mov_b32 v55, 0
    v_mov_b32 v56, 0
    v_mov_b32 v57, 0
    v_mov_b32 v58, 0
    v_mov_b32 v59, 0
    v_mov_b32 v60, 0
    v_mov_b32 v61, 0
    v_mov_b32 v62, 0
    v_mov_b32 v63, 0
    v_mov_b32 v64, 0
    v_mov_b32 v65, 0
    v_mov_b32 v66, 0
    v_mov_b32 v67, 0
    v_mov_b32 v68, 0
    v_mov_b32 v69, 0
    v_mov_b32 v70, 0
    v_mov_b32 v71, 0
    v_mov_b32 v72, 0
    v_mov_b32 v73, 0
    v_mov_b32 v74, 0
    v_mov_b32 v75, 0
    v_mov_b32 v76, 0
    v_mov_b32 v77, 0
    v_mov_b32 v78, 0
    v_mov_b32 v79, 0
    v_mov_b32 v80, 0
    v_mov_b32 v81, 0
    v_mov_b32 v82, 0
    v_mov_b32 v83, 0
    v_mov_b32 v84, 0
    v_mov_b32 v85, 0
    v_mov_b32 v86, 0
    v_mov_b32 v87, 0
    v_mov_b32 v88, 0
    v_mov_b32 v89, 0
    v_mov_b32 v90, 0
    v_mov_b32 v91, 0
    v_mov_b32 v92, 0
    v_mov_b32 v93, 0
    v_mov_b32 v94, 0
    v_mov_b32 v95, 0
    v_mov_b32 v96, 0
    v_mov_b32 v97, 0
    v_mov_b32 v98, 0
    v_mov_b32 v99, 0
    v_mov_b32 v100, 0
    v_mov_b32 v101, 0
    v_mov_b32 v102, 0
    v_mov_b32 v103, 0
    v_mov_b32 v104, 0
    v_mov_b32 v105, 0
    v_mov_b32 v106, 0
    v_mov_b32 v107, 0
    v_mov_b32 v108, 0
    v_mov_b32 v109, 0
    v_mov_b32 v110, 0
    v_mov_b32 v111, 0
    v_mov_b32 v160, v216
    v_mov_b32 v161, v216
    v_mov_b32 v162, v216
    v_mov_b32 v163, v216
    v_mov_b32 v164, v216
    v_mov_b32 v165, v216
    v_mov_b32 v166, v216
    v_mov_b32 v167, v216
    v_mov_b32 v176, v216
    v_mov_b32 v177, v216
    v_mov_b32 v178, v216
    v_mov_b32 v179, v216
    v_mov_b32 v180, v216
    v_mov_b32 v181, v216
    v_mov_b32 v182, v216
    v_mov_b32 v183, v216
    v_mov_b32 v192, v216
    v_mov_b32 v193, v216
    v_mov_b32 v194, v216
    v_mov_b32 v195, v216
    v_mov_b32 v196, v216
    v_mov_b32 v197, v216
    v_mov_b32 v198, v216
    v_mov_b32 v199, v216
    v_mov_b32 v208, v216
    v_mov_b32 v209, v216
    v_mov_b32 v210, v216
    v_mov_b32 v211, v216
    v_mov_b32 v212, v216
    v_mov_b32 v213, v216
    v_mov_b32 v214, v216
    v_mov_b32 v215, v216
    s_setprio 2
    s_lshr_b32 s76, s54, 3
    s_mul_i32 s76, s76, 0
    v_subrev_u32 v217, s76, v6
    s_mov_b32 s96, 0
sw_12:
    ds_read_b32 v216, v217 offset:48
    s_add_u32 s96, s96, 1
    s_waitcnt lgkmcnt(0)
    v_readfirstlane_b32 s97, v216
    s_nop 1
    s_cmp_ge_u32 s97, 4
    s_cbranch_scc1 ok_11
    s_cmp_ge_u32 s96, 160000
    s_cbranch_scc1 ok_11
    s_sleep 1
    s_branch sw_12
ok_11:
    s_mov_b32 s96, 0
pl_13:
    buffer_load_dword v216, v220, s[40:43], s72 offen sc1
    s_add_u32 s96, s96, 1
    s_waitcnt vmcnt(0)
    v_cmp_ne_u32 vcc, 1, v216
    s_cmp_ge_u32 s96, 20000
    s_cbranch_scc1 pl_13_ok
    s_and_b64 vcc, vcc, s[68:69]
    s_cbranch_scc0 pl_13_ok
    s_sleep 1
    s_branch pl_13
pl_13_ok:
    s_mov_b32 s60, 0
    buffer_load_dwordx4 v[152:155], v7, s[24:27], s60 offen offset:0
    buffer_load_dwordx4 v[156:159], v7, s[24:27], s60 offen offset:1024
    s_mov_b64 exec, s[66:67]
    buffer_load_dwordx4 v[160:163], v8, s[24:27], s60 offen
    buffer_load_dwordx4 v[164:167], v9, s[24:27], s60 offen
    s_mov_b64 exec, -1
    s_add_u32 s60, s60, 57344
    buffer_load_dwordx4 v[168:171], v7, s[24:27], s60 offen offset:0
    buffer_load_dwordx4 v[172:175], v7, s[24:27], s60 offen offset:1024
    s_mov_b64 exec, s[66:67]
    buffer_load_dwordx4 v[176:179], v8, s[24:27], s60 offen
    buffer_load_dwordx4 v[180:183], v9, s[24:27], s60 offen
    s_mov_b64 exec, -1
    s_add_u32 s60, s60, 57344
    buffer_load_dwordx4 v[184:187], v7, s[24:27], s60 offen offset:0
    buffer_load_dwordx4 v[188:191], v7, s[24:27], s60 offen offset:1024
    s_mov_b64 exec, s[66:67]
    buffer_load_dwordx4 v[192:195], v8, s[24:27], s60 offen
    buffer_load_dwordx4 v[196:199], v9, s[24:27], s60 offen
    s_mov_b64 exec, -1
    s_add_u32 s60, s60, 57344
    buffer_load_dwordx4 v[200:203], v7, s[24:27], s60 offen offset:0
    buffer_load_dwordx4 v[204:207], v7, s[24:27], s60 offen offset:1024
    buffer_load_dword v225, v226, s[24:27], s75 offen
    s_mov_b32 s61, s60
    s_add_u32 s60, s60, 57344
    s_mov_b32 s62, 4
    s_waitcnt vmcnt(13) lgkmcnt(0)
    v_mfma_f32_32x32x16_bf16 v[112:127], v[152:155], v[16:19], 0
    v_mfma_f32_32x32x16_bf16 v[112:127], v[156:159], v[20:23], v[112:127]
fz_aloop:
    s_nop 11
    v_exp_f32 v112, v112
    v_cvt_pk_bf16_f32 v151, v142, v143
    v_exp_f32 v113, v113
    v_exp_f32 v114, v114
    v_mfma_f32_32x32x16_bf16 v[96:111], v[212:215], v[148:151], v[96:111]
    v_cvt_pk_bf16_f32 v144, v112, v113
    v_exp_f32 v115, v115
    v_exp_f32 v116, v116
    v_cvt_pk_bf16_f32 v145, v114, v115
    v_exp_f32 v117, v117
    v_mfma_f32_32x32x16_bf16 v[128:143], v[152:155], v[24:27], 0
    v_exp_f32 v118, v118
    v_cvt_pk_bf16_f32 v146, v116, v117
    v_exp_f32 v119, v119
    v_exp_f32 v120, v120
    v_cvt_pk_bf16_f32 v147, v118, v119
    v_exp_f32 v121, v121
    v_mfma_f32_32x32x16_bf16 v[128:143], v[156:159], v[28:31], v[128:143]
    v_exp_f32 v122, v122
    v_cvt_pk_bf16_f32 v148, v120, v121
    v_exp_f32 v123, v123
    v_exp_f32 v124, v124
    v_cvt_pk_bf16_f32 v149, v122, v123
    v_exp_f32 v125, v125
    s_waitcnt vmcnt(10)
    v_mfma_f32_32x32x16_bf16 v[48:63], v[160:163], v[144:147], v[48:63]
    v_exp_f32 v126, v126
    v_cvt_pk_bf16_f32 v150, v124, v125
    v_exp_f32 v127, v127
    s_nop 0
    v_exp_f32 v128, v128
    v_cvt_pk_bf16_f32 v151, v126, v127
    v_exp_f32 v129, v129
    v_exp_f32 v130, v130
    v_mfma_f32_32x32x16_bf16 v[48:63], v[164:167], v[148:151], v[48:63]
    v_cvt_pk_bf16_f32 v144, v128, v129
    v_exp_f32 v131, v131
    v_exp_f32 v132, v132
    v_cvt_pk_bf16_f32 v145, v130, v131
    v_exp_f32 v133, v133
    v_mfma_f32_32x32x16_bf16 v[112:127], v[152:155], v[32:35], 0
    v_exp_f32 v134, v134
    v_cvt_pk_bf16_f32 v146, v132, v133
    v_exp_f32 v135, v135
    s_mov_b64 exec, s[66:67]
    buffer_load_dwordx4 v[208:211], v8, s[24:27], s61 offen
    buffer_load_dwordx4 v[212:215], v9, s[24:27], s61 offen
    s_mov_b64 exec, -1
    v_exp_f32 v136, v136
    v_cvt_pk_bf16_f32 v147, v134, v135
    v_exp_f32 v137, v137
    v_mfma_f32_32x32x16_bf16 v[112:127], v[156:159], v[36:39], v[112:127]
    v_exp_f32 v138, v138
    v_cvt_pk_bf16_f32 v148, v136, v137
    v_exp_f32 v139, v139
    v_exp_f32 v140, v140
    v_cvt_pk_bf16_f32 v149, v138, v139
    v_exp_f32 v141, v141
    v_mfma_f32_32x32x16_bf16 v[64:79], v[160:163], v[144:147], v[64:79]
    v_exp_f32 v142, v142
    s_add_u32 s61, s61, 57344
    v_cvt_pk_bf16_f32 v150, v140, v141
    v_exp_f32 v143, v143
    s_nop 0
    v_exp_f32 v112, v112
    v_cvt_pk_bf16_f32 v151, v142, v143
    v_exp_f32 v113, v113
    v_exp_f32 v114, v114
    v_mfma_f32_32x32x16_bf16 v[64:79], v[164:167], v[148:151], v[64:79]
    v_cvt_pk_bf16_f32 v144, v112, v113
    v_exp_f32 v115, v115
    v_exp_f32 v116, v116
    v_cvt_pk_bf16_f32 v145, v114, v115
    v_exp_f32 v117, v117
    v_mfma_f32_32x32x16_bf16 v[128:143], v[152:155], v[40:43], 0
    v_exp_f32 v118, v118
    v_cvt_pk_bf16_f32 v146, v116, v117
    v_exp_f32 v119, v119
    v_exp_f32 v120, v120
    v_cvt_pk_bf16_f32 v147, v118, v119
    v_exp_f32 v121, v121
    v_mfma_f32_32x32x16_bf16 v[128:143], v[156:159], v[44:47], v[128:143]
    v_exp_f32 v122, v122
    v_cvt_pk_bf16_f32 v148, v120, v121
    v_exp_f32 v123, v123
    v_exp_f32 v124, v124
    v_cvt_pk_bf16_f32 v149, v122, v123
    v_exp_f32 v125, v125
    v_mfma_f32_32x32x16_bf16 v[80:95], v[160:163], v[144:147], v[80:95]
    v_exp_f32 v126, v126
    v_cvt_pk_bf16_f32 v150, v124, v125
    v_exp_f32 v127, v127
    s_nop 1
    v_exp_f32 v128, v128
    v_cvt_pk_bf16_f32 v151, v126, v127
    v_exp_f32 v129, v129
    v_exp_f32 v130, v130
    v_mfma_f32_32x32x16_bf16 v[80:95], v[164:167], v[148:151], v[80:95]
    v_cvt_pk_bf16_f32 v144, v128, v129
    v_exp_f32 v131, v131
    v_exp_f32 v132, v132
    v_cvt_pk_bf16_f32 v145, v130, v131
    v_exp_f32 v133, v133
    s_waitcnt vmcnt(10)
    v_mfma_f32_32x32x16_bf16 v[112:127], v[168:171], v[16:19], 0
    v_exp_f32 v134, v134
    v_cvt_pk_bf16_f32 v146, v132, v133
    v_exp_f32 v135, v135
    buffer_load_dwordx4 v[152:155], v7, s[24:27], s60 offen offset:0
    v_exp_f32 v136, v136
    v_cvt_pk_bf16_f32 v147, v134, v135
    v_exp_f32 v137, v137
    v_mfma_f32_32x32x16_bf16 v[112:127], v[172:175], v[20:23], v[112:127]
    v_exp_f32 v138, v138
    v_cvt_pk_bf16_f32 v148, v136, v137
    v_exp_f32 v139, v139
    buffer_load_dwordx4 v[156:159], v7, s[24:27], s60 offen offset:1024
    v_exp_f32 v140, v140
    v_cvt_pk_bf16_f32 v149, v138, v139
    v_exp_f32 v141, v141
    v_mfma_f32_32x32x16_bf16 v[96:111], v[160:163], v[144:147], v[96:111]
    v_exp_f32 v142, v142
    s_add_u32 s60, s60, 57344
    v_cvt_pk_bf16_f32 v150, v140, v141
    v_exp_f32 v143, v143
    v_exp_f32 v112, v112
    v_cvt_pk_bf16_f32 v151, v142, v143
    v_exp_f32 v113, v113
    v_exp_f32 v114, v114
    v_mfma_f32_32x32x16_bf16 v[96:111], v[164:167], v[148:151], v[96:111]
    v_cvt_pk_bf16_f32 v144, v112, v113
    v_exp_f32 v115, v115
    v_exp_f32 v116, v116
    v_cvt_pk_bf16_f32 v145, v114, v115
    v_exp_f32 v117, v117
    v_mfma_f32_32x32x16_bf16 v[128:143], v[168:171], v[24:27], 0
    v_exp_f32 v118, v118
    v_cvt_pk_bf16_f32 v146, v116, v117
    v_exp_f32 v119, v119
    v_exp_f32 v120, v120
    v_cvt_pk_bf16_f32 v147, v118, v119
    v_exp_f32 v121, v121
    v_mfma_f32_32x32x16_bf16 v[128:143], v[172:175], v[28:31], v[128:143]
    v_exp_f32 v122, v122
    v_cvt_pk_bf16_f32 v148, v120, v121
    v_exp_f32 v123, v123
    v_exp_f32 v124, v124
    v_cvt_pk_bf16_f32 v149, v122, v123
    v_exp_f32 v125, v125
    s_waitcnt vmcnt(10)
    v_mfma_f32_32x32x16_bf16 v[48:63], v[176:179], v[144:147], v[48:63]
    v_exp_f32 v126, v126
    v_cvt_pk_bf16_f32 v150, v124, v125
    v_exp_f32 v127, v127
    s_nop 0
    v_exp_f32 v128, v128
    v_cvt_pk_bf16_f32 v151, v126, v127
    v_exp_f32 v129, v129
    v_exp_f32 v130, v130
    v_mfma_f32_32x32x16_bf16 v[48:63], v[180:183], v[148:151], v[48:63]
    v_cvt_pk_bf16_f32 v144, v128, v129
    v_exp_f32 v131, v131
    v_exp_f32 v132, v132
    v_cvt_pk_bf16_f32 v145, v130, v131
    v_exp_f32 v133, v133
    v_mfma_f32_32x32x16_bf16 v[112:127], v[168:171], v[32:35], 0
    v_exp_f32 v134, v134
    v_cvt_pk_bf16_f32 v146, v132, v133
    v_exp_f32 v135, v135
    s_mov_b64 exec, s[66:67]
    buffer_load_dwordx4 v[160:163], v8, s[24:27], s61 offen
    buffer_load_dwordx4 v[164:167], v9, s[24:27], s61 offen
    s_mov_b64 exec, -1
    v_exp_f32 v136, v136
    v_cvt_pk_bf16_f32 v147, v134, v135
    v_exp_f32 v137, v137
    v_mfma_f32_32x32x16_bf16 v[112:127], v[172:175], v[36:39], v[112:127]
    v_exp_f32 v138, v138
    v_cvt_pk_bf16_f32 v148, v136, v137
    v_exp_f32 v139, v139
    v_exp_f32 v140, v140
    v_cvt_pk_bf16_f32 v149, v138, v139
    v_exp_f32 v141, v141
    v_mfma_f32_32x32x16_bf16 v[64:79], v[176:179], v[144:147], v[64:79]
    v_exp_f32 v142, v142
    s_add_u32 s61, s61, 57344
    v_cvt_pk_bf16_f32 v150, v140, v141
    v_exp_f32 v143, v143
    s_nop 0
    v_exp_f32 v112, v112
    v_cvt_pk_bf16_f32 v151, v142, v143
    v_exp_f32 v113, v113
    v_exp_f32 v114, v114
    v_mfma_f32_32x32x16_bf16 v[64:79], v[180:183], v[148:151], v[64:79]
    v_cvt_pk_bf16_f32 v144, v112, v113
    v_exp_f32 v115, v115
    v_exp_f32 v116, v116
    v_cvt_pk_bf16_f32 v145, v114, v115
    v_exp_f32 v117, v117
    v_mfma_f32_32x32x16_bf16 v[128:143], v[168:171], v[40:43], 0
    v_exp_f32 v118, v118
    v_cvt_pk_bf16_f32 v146, v116, v117
    v_exp_f32 v119, v119
    v_exp_f32 v120, v120
    v_cvt_pk_bf16_f32 v147, v118, v119
    v_exp_f32 v121, v121
    v_mfma_f32_32x32x16_bf16 v[128:143], v[172:175], v[44:47], v[128:143]
    v_exp_f32 v122, v122
    v_cvt_pk_bf16_f32 v148, v120, v121
    v_exp_f32 v123, v123
    v_exp_f32 v124, v124
    v_cvt_pk_bf16_f32 v149, v122, v123
    v_exp_f32 v125, v125
    v_mfma_f32_32x32x16_bf16 v[80:95], v[176:179], v[144:147], v[80:95]
    v_exp_f32 v126, v126
    v_cvt_pk_bf16_f32 v150, v124, v125
    v_exp_f32 v127, v127
    s_nop 1
    v_exp_f32 v128, v128
    v_cvt_pk_bf16_f32 v151, v126, v127
    v_exp_f32 v129, v129
    v_exp_f32 v130, v130
    v_mfma_f32_32x32x16_bf16 v[80:95], v[180:183], v[148:151], v[80:95]
    v_cvt_pk_bf16_f32 v144, v128, v129
    v_exp_f32 v131, v131
    v_exp_f32 v132, v132
    v_cvt_pk_bf16_f32 v145, v130, v131
    v_exp_f32 v133, v133
    s_waitcnt vmcnt(10)
    v_mfma_f32_32x32x16_bf16 v[112:127], v[184:187], v[16:19], 0
    v_exp_f32 v134, v134
    v_cvt_pk_bf16_f32 v146, v132, v133
    v_exp_f32 v135, v135
    buffer_load_dwordx4 v[168:171], v7, s[24:27], s60 offen offset:0
    v_exp_f32 v136, v136
    v_cvt_pk_bf16_f32 v147, v134, v135
    v_exp_f32 v137, v137
    v_mfma_f32_32x32x16_bf16 v[112:127], v[188:191], v[20:23], v[112:127]
    v_exp_f32 v138, v138
    v_cvt_pk_bf16_f32 v148, v136, v137
    v_exp_f32 v139, v139
    buffer_load_dwordx4 v[172:175], v7, s[24:27], s60 offen offset:1024
    v_exp_f32 v140, v140
    v_cvt_pk_bf16_f32 v149, v138, v139
    v_exp_f32 v141, v141
    v_mfma_f32_32x32x16_bf16 v[96:111], v[176:179], v[144:147], v[96:111]
    v_exp_f32 v142, v142
    s_add_u32 s60, s60, 57344
    v_cvt_pk_bf16_f32 v150, v140, v141
    v_exp_f32 v143, v143
    v_exp_f32 v112, v112
    v_cvt_pk_bf16_f32 v151, v142, v143
    v_exp_f32 v113, v113
    v_exp_f32 v114, v114
    v_mfma_f32_32x32x16_bf16 v[96:111], v[180:183], v[148:151], v[96:111]
    v_cvt_pk_bf16_f32 v144, v112, v113
    v_exp_f32 v115, v115
    v_exp_f32 v116, v116
    v_cvt_pk_bf16_f32 v145, v114, v115
    v_exp_f32 v117, v117
    v_mfma_f32_32x32x16_bf16 v[128:143], v[184:187], v[24:27], 0
    v_exp_f32 v118, v118
    v_cvt_pk_bf16_f32 v146, v116, v117
    v_exp_f32 v119, v119
    v_exp_f32 v120, v120
    v_cvt_pk_bf16_f32 v147, v118, v119
    v_exp_f32 v121, v121
    v_mfma_f32_32x32x16_bf16 v[128:143], v[188:191], v[28:31], v[128:143]
    v_exp_f32 v122, v122
    v_cvt_pk_bf16_f32 v148, v120, v121
    v_exp_f32 v123, v123
    v_exp_f32 v124, v124
    v_cvt_pk_bf16_f32 v149, v122, v123
    v_exp_f32 v125, v125
    s_waitcnt vmcnt(10)
    v_mfma_f32_32x32x16_bf16 v[48:63], v[192:195], v[144:147], v[48:63]
    v_exp_f32 v126, v126
    v_cvt_pk_bf16_f32 v150, v124, v125
    v_exp_f32 v127, v127
    s_nop 0
    v_exp_f32 v128, v128
    v_cvt_pk_bf16_f32 v151, v126, v127
    v_exp_f32 v129, v129
    v_exp_f32 v130, v130
    v_mfma_f32_32x32x16_bf16 v[48:63], v[196:199], v[148:151], v[48:63]
    v_cvt_pk_bf16_f32 v144, v128, v129
    v_exp_f32 v131, v131
    v_exp_f32 v132, v132
    v_cvt_pk_bf16_f32 v145, v130, v131
    v_exp_f32 v133, v133
    v_mfma_f32_32x32x16_bf16 v[112:127], v[184:187], v[32:35], 0
    v_exp_f32 v134, v134
    v_cvt_pk_bf16_f32 v146, v132, v133
    v_exp_f32 v135, v135
    s_mov_b64 exec, s[66:67]
    buffer_load_dwordx4 v[176:179], v8, s[24:27], s61 offen
    buffer_load_dwordx4 v[180:183], v9, s[24:27], s61 offen
    s_mov_b64 exec, -1
    v_exp_f32 v136, v136
    v_cvt_pk_bf16_f32 v147, v134, v135
    v_exp_f32 v137, v137
    v_mfma_f32_32x32x16_bf16 v[112:127], v[188:191], v[36:39], v[112:127]
    v_exp_f32 v138, v138
    v_cvt_pk_bf16_f32 v148, v136, v137
    v_exp_f32 v139, v139
    v_exp_f32 v140, v140
    v_cvt_pk_bf16_f32 v149, v138, v139
    v_exp_f32 v141, v141
    v_mfma_f32_32x32x16_bf16 v[64:79], v[192:195], v[144:147], v[64:79]
    v_exp_f32 v142, v142
    s_add_u32 s61, s61, 57344
    v_cvt_pk_bf16_f32 v150, v140, v141
    v_exp_f32 v143, v143
    s_nop 0
    v_exp_f32 v112, v112
    v_cvt_pk_bf16_f32 v151, v142, v143
    v_exp_f32 v113, v113
    v_exp_f32 v114, v114
    v_mfma_f32_32x32x16_bf16 v[64:79], v[196:199], v[148:151], v[64:79]
    v_cvt_pk_bf16_f32 v144, v112, v113
    v_exp_f32 v115, v115
    v_exp_f32 v116, v116
    v_cvt_pk_bf16_f32 v145, v114, v115
    v_exp_f32 v117, v117
    v_mfma_f32_32x32x16_bf16 v[128:143], v[184:187], v[40:43], 0
    v_exp_f32 v118, v118
    v_cvt_pk_bf16_f32 v146, v116, v117
    v_exp_f32 v119, v119
    v_exp_f32 v120, v120
    v_cvt_pk_bf16_f32 v147, v118, v119
    v_exp_f32 v121, v121
    v_mfma_f32_32x32x16_bf16 v[128:143], v[188:191], v[44:47], v[128:143]
    v_exp_f32 v122, v122
    v_cvt_pk_bf16_f32 v148, v120, v121
    v_exp_f32 v123, v123
    v_exp_f32 v124, v124
    v_cvt_pk_bf16_f32 v149, v122, v123
    v_exp_f32 v125, v125
    v_mfma_f32_32x32x16_bf16 v[80:95], v[192:195], v[144:147], v[80:95]
    v_exp_f32 v126, v126
    v_cvt_pk_bf16_f32 v150, v124, v125
    v_exp_f32 v127, v127
    s_nop 1
    v_exp_f32 v128, v128
    v_cvt_pk_bf16_f32 v151, v126, v127
    v_exp_f32 v129, v129
    v_exp_f32 v130, v130
    v_mfma_f32_32x32x16_bf16 v[80:95], v[196:199], v[148:151], v[80:95]
    v_cvt_pk_bf16_f32 v144, v128, v129
    v_exp_f32 v131, v131
    v_exp_f32 v132, v132
    v_cvt_pk_bf16_f32 v145, v130, v131
    v_exp_f32 v133, v133
    s_waitcnt vmcnt(10)
    v_mfma_f32_32x32x16_bf16 v[112:127], v[200:203], v[16:19], 0
    v_exp_f32 v134, v134
    v_cvt_pk_bf16_f32 v146, v132, v133
    v_exp_f32 v135, v135
    buffer_load_dwordx4 v[184:187], v7, s[24:27], s60 offen offset:0
    v_exp_f32 v136, v136
    v_cvt_pk_bf16_f32 v147, v134, v135
    v_exp_f32 v137, v137
    v_mfma_f32_32x32x16_bf16 v[112:127], v[204:207], v[20:23], v[112:127]
    v_exp_f32 v138, v138
    v_cvt_pk_bf16_f32 v148, v136, v137
    v_exp_f32 v139, v139
    buffer_load_dwordx4 v[188:191], v7, s[24:27], s60 offen offset:1024
    v_exp_f32 v140, v140
    v_cvt_pk_bf16_f32 v149, v138, v139
    v_exp_f32 v141, v141
    v_mfma_f32_32x32x16_bf16 v[96:111], v[192:195], v[144:147], v[96:111]
    v_exp_f32 v142, v142
    s_add_u32 s60, s60, 57344
    v_cvt_pk_bf16_f32 v150, v140, v141
    v_exp_f32 v143, v143
    v_exp_f32 v112, v112
    v_cvt_pk_bf16_f32 v151, v142, v143
    v_exp_f32 v113, v113
    v_exp_f32 v114, v114
    v_mfma_f32_32x32x16_bf16 v[96:111], v[196:199], v[148:151], v[96:111]
    v_cvt_pk_bf16_f32 v144, v112, v113
    v_exp_f32 v115, v115
    v_exp_f32 v116, v116
    v_cvt_pk_bf16_f32 v145, v114, v115
    v_exp_f32 v117, v117
    v_mfma_f32_32x32x16_bf16 v[128:143], v[200:203], v[24:27], 0
    v_exp_f32 v118, v118
    v_cvt_pk_bf16_f32 v146, v116, v117
    v_exp_f32 v119, v119
    v_exp_f32 v120, v120
    v_cvt_pk_bf16_f32 v147, v118, v119
    v_exp_f32 v121, v121
    v_mfma_f32_32x32x16_bf16 v[128:143], v[204:207], v[28:31], v[128:143]
    v_exp_f32 v122, v122
    v_cvt_pk_bf16_f32 v148, v120, v121
    v_exp_f32 v123, v123
    v_exp_f32 v124, v124
    v_cvt_pk_bf16_f32 v149, v122, v123
    v_exp_f32 v125, v125
    s_waitcnt vmcnt(10)
    v_mfma_f32_32x32x16_bf16 v[48:63], v[208:211], v[144:147], v[48:63]
    v_exp_f32 v126, v126
    v_cvt_pk_bf16_f32 v150, v124, v125
    v_exp_f32 v127, v127
    s_nop 0
    v_exp_f32 v128, v128
    v_cvt_pk_bf16_f32 v151, v126, v127
    v_exp_f32 v129, v129
    v_exp_f32 v130, v130
    v_mfma_f32_32x32x16_bf16 v[48:63], v[212:215], v[148:151], v[48:63]
    v_cvt_pk_bf16_f32 v144, v128, v129
    v_exp_f32 v131, v131
    v_exp_f32 v132, v132
    v_cvt_pk_bf16_f32 v145, v130, v131
    v_exp_f32 v133, v133
    v_mfma_f32_32x32x16_bf16 v[112:127], v[200:203], v[32:35], 0
    v_exp_f32 v134, v134
    v_cvt_pk_bf16_f32 v146, v132, v133
    v_exp_f32 v135, v135
    s_mov_b64 exec, s[66:67]
    buffer_load_dwordx4 v[192:195], v8, s[24:27], s61 offen
    buffer_load_dwordx4 v[196:199], v9, s[24:27], s61 offen
    s_mov_b64 exec, -1
    v_exp_f32 v136, v136
    v_cvt_pk_bf16_f32 v147, v134, v135
    v_exp_f32 v137, v137
    v_mfma_f32_32x32x16_bf16 v[112:127], v[204:207], v[36:39], v[112:127]
    v_exp_f32 v138, v138
    v_cvt_pk_bf16_f32 v148, v136, v137
    v_exp_f32 v139, v139
    v_exp_f32 v140, v140
    v_cvt_pk_bf16_f32 v149, v138, v139
    v_exp_f32 v141, v141
    v_mfma_f32_32x32x16_bf16 v[64:79], v[208:211], v[144:147], v[64:79]
    v_exp_f32 v142, v142
    s_add_u32 s61, s61, 57344
    v_cvt_pk_bf16_f32 v150, v140, v141
    v_exp_f32 v143, v143
    s_nop 0
    v_exp_f32 v112, v112
    v_cvt_pk_bf16_f32 v151, v142, v143
    v_exp_f32 v113, v113
    v_exp_f32 v114, v114
    v_mfma_f32_32x32x16_bf16 v[64:79], v[212:215], v[148:151], v[64:79]
    v_cvt_pk_bf16_f32 v144, v112, v113
    v_exp_f32 v115, v115
    v_exp_f32 v116, v116
    v_cvt_pk_bf16_f32 v145, v114, v115
    v_exp_f32 v117, v117
    v_mfma_f32_32x32x16_bf16 v[128:143], v[200:203], v[40:43], 0
    v_exp_f32 v118, v118
    v_cvt_pk_bf16_f32 v146, v116, v117
    v_exp_f32 v119, v119
    v_exp_f32 v120, v120
    v_cvt_pk_bf16_f32 v147, v118, v119
    v_exp_f32 v121, v121
    v_mfma_f32_32x32x16_bf16 v[128:143], v[204:207], v[44:47], v[128:143]
    v_exp_f32 v122, v122
    v_cvt_pk_bf16_f32 v148, v120, v121
    v_exp_f32 v123, v123
    v_exp_f32 v124, v124
    v_cvt_pk_bf16_f32 v149, v122, v123
    v_exp_f32 v125, v125
    v_mfma_f32_32x32x16_bf16 v[80:95], v[208:211], v[144:147], v[80:95]
    v_exp_f32 v126, v126
    v_cvt_pk_bf16_f32 v150, v124, v125
    v_exp_f32 v127, v127
    s_nop 1
    v_exp_f32 v128, v128
    v_cvt_pk_bf16_f32 v151, v126, v127
    v_exp_f32 v129, v129
    v_exp_f32 v130, v130
    v_mfma_f32_32x32x16_bf16 v[80:95], v[212:215], v[148:151], v[80:95]
    v_cvt_pk_bf16_f32 v144, v128, v129
    v_exp_f32 v131, v131
    v_exp_f32 v132, v132
    v_cvt_pk_bf16_f32 v145, v130, v131
    v_exp_f32 v133, v133
    s_waitcnt vmcnt(10)
    v_mfma_f32_32x32x16_bf16 v[112:127], v[152:155], v[16:19], 0
    v_exp_f32 v134, v134
    v_cvt_pk_bf16_f32 v146, v132, v133
    v_exp_f32 v135, v135
    buffer_load_dwordx4 v[200:203], v7, s[24:27], s60 offen offset:0
    v_exp_f32 v136, v136
    v_cvt_pk_bf16_f32 v147, v134, v135
    v_exp_f32 v137, v137
    v_mfma_f32_32x32x16_bf16 v[112:127], v[156:159], v[20:23], v[112:127]
    v_exp_f32 v138, v138
    v_cvt_pk_bf16_f32 v148, v136, v137
    v_exp_f32 v139, v139
    buffer_load_dwordx4 v[204:207], v7, s[24:27], s60 offen offset:1024
    v_exp_f32 v140, v140
    v_cvt_pk_bf16_f32 v149, v138, v139
    v_exp_f32 v141, v141
    v_mfma_f32_32x32x16_bf16 v[96:111], v[208:211], v[144:147], v[96:111]
    v_exp_f32 v142, v142
    s_add_u32 s60, s60, 57344
    v_cvt_pk_bf16_f32 v150, v140, v141
    v_exp_f32 v143, v143
    s_sub_u32 s62, s62, 1
    s_cmp_lg_u32 s62, 0
    s_cbranch_scc1 fz_aloop
    v_cvt_pk_bf16_f32 v151, v142, v143
    s_nop 1
    v_mfma_f32_32x32x16_bf16 v[96:111], v[212:215], v[148:151], v[96:111]
fz_xp:
    s_xor_b32 s70, s50, 1
    s_mul_i32 s70, s70, 12288
    s_add_u32 s70, s70, 0
    v_add_u32 v217, s70, v15
    s_xor_b32 s70, s50, 2
    s_mul_i32 s70, s70, 12288
    s_add_u32 s70, s70, 4096
    v_add_u32 v218, s70, v15
    s_xor_b32 s70, s50, 3
    s_mul_i32 s70, s70, 12288
    s_add_u32 s70, s70, 8192
    v_add_u32 v219, s70, v15
    s_mul_i32 s70, s50, 12288
    v_add_u32 v216, s70, v15
    v_min_u32 v222, 6, v1
    v_lshlrev_b32 v222, 14, v222
    s_mov_b32 s96, 0
sw_15:
    ds_read_b32 v220, v6 offset:16
    s_add_u32 s96, s96, 1
    s_waitcnt lgkmcnt(0)
    v_readfirstlane_b32 s97, v220
    s_nop 1
    s_cmp_ge_u32 s97, 4
    s_cbranch_scc1 ok_14
    s_cmp_ge_u32 s96, 160000
    s_cbranch_scc1 ok_14
    s_sleep 1
    s_branch sw_15
ok_14:
    ds_write_b128 v217, v[64:67] offset:0
    ds_write_b128 v217, v[68:71] offset:1024
    ds_write_b128 v217, v[72:75] offset:2048
    ds_write_b128 v217, v[76:79] offset:3072
    ds_write_b128 v218, v[80:83] offset:0
    ds_write_b128 v218, v[84:87] offset:1024
    ds_write_b128 v218, v[88:91] offset:2048
    ds_write_b128 v218, v[92:95] offset:3072
    ds_write_b128 v219, v[96:99] offset:0
    ds_write_b128 v219, v[100:103] offset:1024
    ds_write_b128 v219, v[104:107] offset:2048
    ds_write_b128 v219, v[108:111] offset:3072
    ds_add_u32 v2, v3 offset:20
    s_mov_b32 s96, 0
sw_17:
    ds_read_b32 v220, v6 offset:20
    s_add_u32 s96, s96, 1
    s_waitcnt lgkmcnt(0)
    v_readfirstlane_b32 s97, v220
    s_nop 1
    s_cmp_ge_u32 s97, 4
    s_cbranch_scc1 ok_16
    s_cmp_ge_u32 s96, 160000
    s_cbranch_scc1 ok_16
    s_sleep 1
    s_branch sw_17
ok_16:
    ds_read_b128 v[64:67], v216 offset:0
    ds_read_b128 v[68:71], v216 offset:1024
    ds_read_b128 v[72:75], v216 offset:2048
    ds_read_b128 v[76:79], v216 offset:3072
    ds_read_b128 v[80:83], v216 offset:4096
    ds_read_b128 v[84:87], v216 offset:5120
    ds_read_b128 v[88:91], v216 offset:6144
    ds_read_b128 v[92:95], v216 offset:7168
    ds_read_b128 v[96:99], v216 offset:8192
    ds_read_b128 v[100:103], v216 offset:9216
    ds_read_b128 v[104:107], v216 offset:10240
    ds_read_b128 v[108:111], v216 offset:11264
    s_waitcnt lgkmcnt(11)
    v_add_f32 v48, v48, v64
    v_add_f32 v49, v49, v65
    v_add_f32 v50, v50, v66
    v_add_f32 v51, v51, v67
    s_waitcnt lgkmcnt(10)
    v_add_f32 v52, v52, v68
    v_add_f32 v53, v53, v69
    v_add_f32 v54, v54, v70
    v_add_f32 v55, v55, v71
    s_waitcnt lgkmcnt(9)
    v_add_f32 v56, v56, v72
    v_add_f32 v57, v57, v73
    v_add_f32 v58, v58, v74
    v_add_f32 v59, v59, v75
    s_waitcnt lgkmcnt(8)
    v_add_f32 v60, v60, v76
    v_add_f32 v61, v61, v77
    v_add_f32 v62, v62, v78
    v_add_f32 v63, v63, v79
    s_waitcnt lgkmcnt(7)
    v_add_f32 v48, v48, v80
    v_add_f32 v49, v49, v81
    v_add_f32 v50, v50, v82
    v_add_f32 v51, v51, v83
    s_waitcnt lgkmcnt(6)
    v_add_f32 v52, v52, v84
    v_add_f32 v53, v53, v85
    v_add_f32 v54, v54, v86
    v_add_f32 v55, v55, v87
    s_waitcnt lgkmcnt(5)
    v_add_f32 v56, v56, v88
    v_add_f32 v57, v57, v89
    v_add_f32 v58, v58, v90
    v_add_f32 v59, v59, v91
    s_waitcnt lgkmcnt(4)
    v_add_f32 v60, v60, v92
    v_add_f32 v61, v61, v93
    v_add_f32 v62, v62, v94
    v_add_f32 v63, v63, v95
    s_waitcnt lgkmcnt(3)
    v_add_f32 v48, v48, v96
    v_add_f32 v49, v49, v97
    v_add_f32 v50, v50, v98
    v_add_f32 v51, v51, v99
    s_waitcnt lgkmcnt(2)
    v_add_f32 v52, v52, v100
    v_add_f32 v53, v53, v101
    v_add_f32 v54, v54, v102
    v_add_f32 v55, v55, v103
    s_waitcnt lgkmcnt(1)
    v_add_f32 v56, v56, v104
    v_add_f32 v57, v57, v105
    v_add_f32 v58, v58, v106
    v_add_f32 v59, v59, v107
    s_waitcnt lgkmcnt(0)
    v_add_f32 v60, v60, v108
    v_add_f32 v61, v61, v109
    v_add_f32 v62, v62, v110
    v_add_f32 v63, v63, v111
    v_mov_b32 v216, v60
    v_mov_b32 v217, v60
    s_nop 1
    v_permlane32_swap_b32 v216, v217
    v_mul_f32 v218, 0, v48
    v_fmac_f32 v218, 0, v49
    v_fmac_f32 v218, 0, v50
    v_fmac_f32 v218, 0, v51
    v_fmac_f32 v218, 0, v52
    v_fmac_f32 v218, 0, v53
    v_fmac_f32 v218, 0, v54
    v_fmac_f32 v218, 0, v55
    v_fmac_f32 v218, 0, v56
    v_fmac_f32 v218, 0, v57
    v_fmac_f32 v218, 0, v58
    v_fmac_f32 v218, 0, v59
    v_fmac_f32 v218, 0, v60
    v_fmac_f32 v218, 0, v61
    v_fmac_f32 v218, 0, v62
    v_fmac_f32 v218, 0, v63
    v_add_f32 v218, v218, v217
    v_cmp_nle_f32 vcc, 0x21800000, v218
    v_mov_b32 v219, 0x5d800000
    v_cmp_nge_f32 s[70:71], v219, v218
    s_nop 1
    s_or_b64 vcc, vcc, s[70:71]
    s_cbranch_vccnz fz_slow
fz_norm:
    v_rcp_f32 v218, v217
    s_nop 0
    v_mul_f32 v48, v48, v218
    v_mul_f32 v49, v49, v218
    v_mul_f32 v50, v50, v218
    v_mul_f32 v51, v51, v218
    v_mul_f32 v52, v52, v218
    v_mul_f32 v53, v53, v218
    v_mul_f32 v54, v54, v218
    v_mul_f32 v55, v55, v218
    v_mul_f32 v56, v56, v218
    v_mul_f32 v57, v57, v218
    v_mul_f32 v58, v58, v218
    v_mul_f32 v59, v59, v218
    v_mul_f32 v60, v60, v218
    v_mul_f32 v61, v61, v218
    v_mul_f32 v62, v62, v218
    v_mul_f32 v63, v63, v218
    v_cvt_pk_bf16_f32 v144, v48, v49
    v_cvt_pk_bf16_f32 v145, v50, v51
    v_cvt_pk_bf16_f32 v146, v52, v53
    v_cvt_pk_bf16_f32 v147, v54, v55
    v_cvt_pk_bf16_f32 v148, v56, v57
    v_cvt_pk_bf16_f32 v149, v58, v59
    v_cvt_pk_bf16_f32 v150, v60, v61
    v_cvt_pk_bf16_f32 v151, v62, v63
    v_cndmask_b32 v150, v150, 0, s[56:57]
    v_cndmask_b32 v151, v151, 0, s[56:57]
    buffer_store_dwordx4 v[144:147], v15, s[40:43], s63 offen sc1
    buffer_store_dwordx4 v[148:151], v15, s[40:43], s63 offen offset:1024 sc1
    buffer_store_dword v3, v222, s[40:43], s64 offen sc1
    ds_add_u32 v2, v3 offset:4
    s_endpgm
fz_slow:
    v_mov_b32 v220, 0xff800000
    s_mov_b32 s60, 0
fz_slow1:
    buffer_load_dwordx4 v[152:155], v7, s[28:31], s60 offen offset:0
    buffer_load_dwordx4 v[156:159], v7, s[28:31], s60 offen offset:1024
    s_waitcnt vmcnt(0)
    v_mfma_f32_32x32x16_bf16 v[112:127], v[152:155], v[16:19], 0
    v_mfma_f32_32x32x16_bf16 v[112:127], v[156:159], v[20:23], v[112:127]
    s_nop 11
    v_max3_f32 v220, v220, v112, v113
    v_max3_f32 v220, v220, v114, v115
    v_max3_f32 v220, v220, v116, v117
    v_max3_f32 v220, v220, v118, v119
    v_max3_f32 v220, v220, v120, v121
    v_max3_f32 v220, v220, v122, v123
    v_max3_f32 v220, v220, v124, v125
    v_max3_f32 v220, v220, v126, v127
    s_add_u32 s60, s60, 57344
    s_cmp_lt_u32 s60, 3670016
    s_cbranch_scc1 fz_slow1
    v_mov_b32 v221, v220
    s_nop 1
    v_permlane32_swap_b32 v220, v221
    v_max_f32 v220, v220, v221
    s_mov_b32 s60, 0
    v_mov_b32 v48, 0
    v_mov_b32 v49, 0
    v_mov_b32 v50, 0
    v_mov_b32 v51, 0
    v_mov_b32 v52, 0
    v_mov_b32 v53, 0
    v_mov_b32 v54, 0
    v_mov_b32 v55, 0
    v_mov_b32 v56, 0
    v_mov_b32 v57, 0
    v_mov_b32 v58, 0
    v_mov_b32 v59, 0
    v_mov_b32 v60, 0
    v_mov_b32 v61, 0
    v_mov_b32 v62, 0
    v_mov_b32 v63, 0
fz_slow2:
    buffer_load_dwordx4 v[152:155], v7, s[28:31], s60 offen offset:0
    buffer_load_dwordx4 v[156:159], v7, s[28:31], s60 offen offset:1024
    s_mov_b64 exec, s[66:67]
    buffer_load_dwordx4 v[160:163], v8, s[28:31], s60 offen
    buffer_load_dwordx4 v[164:167], v9, s[28:31], s60 offen
    s_mov_b64 exec, -1
    s_waitcnt vmcnt(0)
    v_mfma_f32_32x32x16_bf16 v[112:127], v[152:155], v[16:19], 0
    v_mfma_f32_32x32x16_bf16 v[112:127], v[156:159], v[20:23], v[112:127]
    s_nop 11
    v_sub_f32 v112, v112, v220
    v_sub_f32 v113, v113, v220
    v_sub_f32 v114, v114, v220
    v_sub_f32 v115, v115, v220
    v_sub_f32 v116, v116, v220
    v_sub_f32 v117, v117, v220
    v_sub_f32 v118, v118, v220
    v_sub_f32 v119, v119, v220
    v_sub_f32 v120, v120, v220
    v_sub_f32 v121, v121, v220
    v_sub_f32 v122, v122, v220
    v_sub_f32 v123, v123, v220
    v_sub_f32 v124, v124, v220
    v_sub_f32 v125, v125, v220
    v_sub_f32 v126, v126, v220
    v_sub_f32 v127, v127, v220
    v_exp_f32 v112, v112
    v_exp_f32 v113, v113
    v_exp_f32 v114, v114
    v_exp_f32 v115, v115
    v_exp_f32 v116, v116
    v_exp_f32 v117, v117
    v_exp_f32 v118, v118
    v_exp_f32 v119, v119
    v_exp_f32 v120, v120
    v_exp_f32 v121, v121
    v_exp_f32 v122, v122
    v_exp_f32 v123, v123
    v_exp_f32 v124, v124
    v_exp_f32 v125, v125
    v_exp_f32 v126, v126
    v_exp_f32 v127, v127
    v_cvt_pk_bf16_f32 v144, v112, v113
    v_cvt_pk_bf16_f32 v145, v114, v115
    v_cvt_pk_bf16_f32 v146, v116, v117
    v_cvt_pk_bf16_f32 v147, v118, v119
    v_cvt_pk_bf16_f32 v148, v120, v121
    v_cvt_pk_bf16_f32 v149, v122, v123
    v_cvt_pk_bf16_f32 v150, v124, v125
    v_cvt_pk_bf16_f32 v151, v126, v127
    v_mfma_f32_32x32x16_bf16 v[48:63], v[160:163], v[144:147], v[48:63]
    s_nop 0
    v_mfma_f32_32x32x16_bf16 v[48:63], v[164:167], v[148:151], v[48:63]
    s_add_u32 s60, s60, 57344
    s_cmp_lt_u32 s60, 3670016
    s_cbranch_scc1 fz_slow2
    s_nop 8
    v_mov_b32 v216, v60
    v_mov_b32 v217, v60
    s_nop 1
    v_permlane32_swap_b32 v216, v217
    s_branch fz_norm
fz_g:
    s_mov_b32 s40, s22
    s_mov_b32 s41, s23
    s_mov_b32 s42, 268435456
    s_mov_b32 s43, 0x20000
    s_setprio 2
    s_add_u32 m0, s51, 90112
    s_nop 0
    buffer_load_dwordx4 v124, s[24:27], s52 offen lds
    s_mov_b32 s44, s20
    s_mov_b32 s45, s21
    s_mov_b32 s46, 256
    s_mov_b32 s47, 0x20000
    s_mov_b32 s55, 0x3f803f80
    s_mov_b32 s56, 0
    s_mov_b32 s57, -1
    s_lshl_b32 s59, s48, 4
    s_add_u32 s59, s59, s49
    s_lshl_b32 s59, s59, 2
    v_lshlrev_b32 v16, 2, v1
    v_add_u32 v17, 163328, v16
    v_mov_b32 v6, 163072
    v_cmp_eq_u32 vcc, 0, v1
    s_nop 1
    v_cndmask_b32 v2, v17, v6, vcc
    s_add_u32 m0, s51, 94208
    s_nop 0
    buffer_load_dwordx4 v125, s[24:27], s52 offen lds
    v_mov_b32 v3, 1
    s_mul_i32 s75, s49, 224
    v_and_b32 v100, 31, v1
    v_lshrrev_b32 v101, 5, v1
    v_bfe_u32 v102, v1, 2, 2
    v_xor_b32 v103, v101, v102
    v_lshlrev_b32 v103, 4, v103
    v_and_b32 v104, 7, v1
    v_lshl_add_u32 v103, v104, 6, v103
    v_bfe_u32 v104, v1, 3, 2
    v_lshl_add_u32 v103, v104, 10, v103
    v_bfe_u32 v104, v1, 4, 1
    v_and_b32 v105, 3, v1
    v_lshlrev_b32 v105, 3, v105
    s_add_u32 m0, s51, 24576
    s_nop 0
    buffer_load_dwordx4 v5, s[28:31], s53 offen lds
    s_add_u32 s52, s52, 128
    s_add_u32 s53, s53, 172032
    s_cmp_eq_u32 s52, 896
    s_cselect_b32 s52, 0, s52
    s_cselect_b32 s53, 0, s53
    s_lshl_b32 s62, s58, 10
    s_and_b32 s73, s58, 1
    s_lshr_b32 s74, s58, 1
    s_lshl_b32 s63, s73, 1
    s_add_u32 s63, s63, s74
    s_lshl_b32 s64, s74, 2
    s_lshl_b32 s76, s73, 5
    v_xor_b32 v103, s76, v103
    s_lshl_b32 s76, s63, 12
    s_add_u32 s76, s76, 65536
    v_add_u32 v7, s76, v103
    v_xor_b32 v8, 32, v7
    v_xor_b32 v9, 4096, v7
    v_xor_b32 v10, 4096, v8
    s_setprio 1
    s_add_u32 m0, s51, 106496
    s_nop 0
    buffer_load_dwordx4 v124, s[24:27], s52 offen lds
    v_add_u32 v11, 65536, v7
    v_add_u32 v12, 65536, v8
    v_add_u32 v13, 65536, v9
    v_add_u32 v14, 65536, v10
    v_lshlrev_b32 v15, 4, v1
    v_lshl_add_u32 v106, v101, 3, v102
    v_lshlrev_b32 v106, 6, v106
    v_lshl_add_u32 v106, v104, 5, v106
    v_add_u32 v106, v106, v105
    s_lshl_b32 s76, s73, 10
    s_add_u32 s76, s76, 8192
    v_add_u32 v250, s76, v106
    v_xor_b32 v251, 1024, v250
    v_and_b32 v106, 15, v1
    v_bfe_u32 v107, v1, 4, 1
    s_add_u32 m0, s51, 110592
    s_nop 0
    buffer_load_dwordx4 v125, s[24:27], s52 offen lds
    v_lshlrev_b32 v107, 2, v107
    v_cmp_eq_u32 vcc, v106, v107
    v_mov_b32 v106, s55
    s_nop 0
    v_cndmask_b32 v246, 0, v106, vcc
    v_cndmask_b32 v247, 0, v106, vcc
    v_cndmask_b32 v248, 0, v106, vcc
    v_cndmask_b32 v249, 0, v106, vcc
    s_bitcmp1_b32 s49, 0
    s_cselect_b32 s60, 1, 0x10000000
    s_cselect_b32 s76, 0, 56
    s_mov_b32 s61, s60
    v_mov_b32 v120, s55
    s_add_u32 s76, s76, s51
    v_and_b32 v121, 15, v1
    v_lshlrev_b32 v121, 6, v121
    v_add_u32 v121, s76, v121
    s_add_u32 m0, s51, 40960
    s_nop 0
    buffer_load_dwordx4 v5, s[28:31], s53 offen lds
    s_add_u32 s52, s52, 128
    s_add_u32 s53, s53, 172032
    s_cmp_eq_u32 s52, 896
    s_cselect_b32 s52, 0, s52
    s_cselect_b32 s53, 0, s53
    s_add_u32 s77, s49, 7
    s_lshl_b32 s77, s77, 7
    s_cmp_lt_u32 s49, 14
    s_cselect_b32 s77, s77, 1073741824
    v_lshrrev_b32 v106, 3, v1
    s_lshl_b32 s78, s58, 3
    v_add_u32 v106, s78, v106
    v_bfe_u32 v107, v106, 1, 1
    v_lshlrev_b32 v107, 2, v107
    v_and_b32 v108, 7, v1
    v_xor_b32 v107, v107, v108
    v_mul_u32_u24 v106, 2688, v106
    v_lshl_add_u32 v106, v107, 4, v106
    v_add_u32 v126, s77, v106
    v_add_u32 v127, 86016, v126
    s_setprio 3
    s_waitcnt vmcnt(6) lgkmcnt(0)
    s_barrier
    ds_read_b128 v[176:179], v7 offset:0
    ds_read_b64_tr_b16 v[36:37], v250 offset:0
    ds_read_b64_tr_b16 v[38:39], v250 offset:256
    ds_read_b128 v[180:183], v9 offset:0
    ds_read_b128 v[184:187], v8 offset:0
    ds_read_b64_tr_b16 v[44:45], v251 offset:0
    ds_read_b64_tr_b16 v[46:47], v251 offset:256
    ds_read_b128 v[188:191], v10 offset:0
    ds_read_b128 v[192:195], v7 offset:512
    ds_read_b64_tr_b16 v[52:53], v250 offset:2048
    ds_read_b64_tr_b16 v[54:55], v250 offset:2304
    ds_read_b128 v[196:199], v9 offset:512
    ds_read_b128 v[200:203], v8 offset:512
    ds_read_b64_tr_b16 v[60:61], v251 offset:2048
    ds_read_b64_tr_b16 v[62:63], v251 offset:2304
    ds_read_b128 v[204:207], v10 offset:512
    s_mov_b32 s32, s12
    s_mov_b32 s33, s13
    s_mov_b32 s34, 1605632
    s_mov_b32 s35, 0x20000
    s_mov_b32 s36, s14
    s_mov_b32 s37, s15
    s_mov_b32 s38, 1605632
    s_mov_b32 s39, 0x20000
    v_mul_u32_u24 v106, 224, v102
    v_lshl_add_u32 v106, v101, 11, v106
    v_mul_u32_u24 v107, 4224, v104
    v_add3_u32 v106, v106, v107, v105
    s_lshl_b32 s76, s73, 13
    s_lshl_b32 s77, s64, 5
    s_add_u32 s77, s77, s76
    s_add_u32 s76, s76, 96
    v_add_u32 v240, s77, v106
    v_xor_b32 v241, 8192, v240
    v_add_u32 v242, s76, v106
    v_xor_b32 v243, 8192, v242
    s_mul_i32 s76, s58, 14336
    s_add_u32 s76, s76, s75
    v_mov_b32 v110, 1073741824
    v_mov_b32 v106, v1
    v_mul_u32_u24 v107, 4682, v106
    v_lshrrev_b32 v107, 16, v107
    v_mul_u32_u24 v108, 14, v107
    v_sub_u32 v108, v106, v108
    v_mul_u32_u24 v107, 3584, v107
    v_lshl_add_u32 v107, v108, 4, v107
    v_add_u32 v107, s76, v107
    v_cmp_gt_u32 vcc, 56, v106
    s_nop 1
    v_cndmask_b32 v244, v110, v107, vcc
    v_subrev_u32 v106, 8, v1
    v_and_b32 v106, 63, v106
    v_mul_u32_u24 v107, 4682, v106
    v_lshrrev_b32 v107, 16, v107
    v_mul_u32_u24 v108, 14, v107
    v_sub_u32 v108, v106, v108
    v_mul_u32_u24 v107, 3584, v107
    s_waitcnt lgkmcnt(13)
    v_cndmask_b32 v36, v36, v120, s[60:61]
    v_cndmask_b32 v37, v37, v120, s[60:61]
    v_cndmask_b32 v38, v38, v120, s[60:61]
    v_cndmask_b32 v39, v39, v120, s[60:61]
    s_nop 1
    v_mfma_f32_32x32x16_bf16 v[16:31], v[36:39], v[176:179], 0
    v_mfma_f32_4x4x4_16b_bf16 v[112:115], v[176:177], v[176:177], 0
    v_mfma_f32_16x16x32_bf16 v[96:99], v[246:249], v[36:39], 0
    v_mfma_f32_4x4x4_16b_bf16 v[116:119], v[178:179], v[178:179], 0
    s_add_u32 m0, s51, 114688
    s_nop 0
    buffer_load_dwordx4 v4, s[24:27], s52 offen lds
    s_add_u32 m0, s51, 118784
    s_nop 0
    buffer_load_dwordx4 v123, s[24:27], s52 offen lds
    s_add_u32 m0, s51, 122880
    s_nop 0
    buffer_load_dwordx4 v124, s[24:27], s52 offen lds
    s_add_u32 m0, s51, 126976
    s_nop 0
    buffer_load_dwordx4 v125, s[24:27], s52 offen lds
    s_waitcnt lgkmcnt(9)
    v_cndmask_b32 v44, v44, v120, s[60:61]
    v_cndmask_b32 v45, v45, v120, s[60:61]
    v_cndmask_b32 v46, v46, v120, s[60:61]
    v_cndmask_b32 v47, v47, v120, s[60:61]
    s_waitcnt vmcnt(7)
    ds_write_b16 v121, v120 offset:24576
    v_mfma_f32_32x32x16_bf16 v[16:31], v[44:47], v[184:187], v[16:31]
    v_mfma_f32_4x4x4_16b_bf16 v[112:115], v[184:185], v[184:185], v[112:115]
    v_mfma_f32_4x4x4_16b_bf16 v[116:119], v[186:187], v[186:187], v[116:119]
    s_add_u32 m0, s51, 49152
    s_nop 0
    buffer_load_dwordx4 v126, s[28:31], s53 offen lds
    s_add_u32 m0, s51, 53248
    s_nop 0
    buffer_load_dwordx4 v127, s[28:31], s53 offen lds
    s_add_u32 m0, s51, 57344
    s_nop 0
    buffer_load_dwordx4 v5, s[28:31], s53 offen lds
    s_add_u32 s52, s52, 128
    s_add_u32 s53, s53, 172032
    s_cmp_eq_u32 s52, 896
    s_cselect_b32 s52, 0, s52
    s_cselect_b32 s53, 0, s53
    s_waitcnt vmcnt(10) lgkmcnt(0)
    s_barrier
    v_cndmask_b32 v52, v52, v120, s[60:61]
    v_cndmask_b32 v53, v53, v120, s[60:61]
    v_cndmask_b32 v54, v54, v120, s[60:61]
    v_cndmask_b32 v55, v55, v120, s[60:61]
    s_nop 1
    v_mfma_f32_32x32x16_bf16 v[16:31], v[52:55], v[192:195], v[16:31]
    ds_read_b128 v[208:211], v7 offset:16384
    ds_read_b64_tr_b16 v[68:69], v250 offset:16384
    ds_read_b64_tr_b16 v[70:71], v250 offset:16640
    ds_read_b128 v[212:215], v9 offset:16384
    v_mfma_f32_4x4x4_16b_bf16 v[112:115], v[192:193], v[192:193], v[112:115]
    v_mfma_f32_16x16x32_bf16 v[96:99], v[246:249], v[52:55], v[96:99]
    v_mfma_f32_4x4x4_16b_bf16 v[116:119], v[194:195], v[194:195], v[116:119]
    s_add_u32 m0, s51, 131072
    s_nop 0
    buffer_load_dwordx4 v4, s[24:27], s52 offen lds
    s_add_u32 m0, s51, 135168
    s_nop 0
    buffer_load_dwordx4 v123, s[24:27], s52 offen lds
    v_lshl_add_u32 v107, v108, 4, v107
    v_add_u32 v107, s76, v107
    v_cmp_gt_u32 vcc, 56, v106
    s_nop 1
    v_cndmask_b32 v245, v110, v107, vcc
    s_lshl_b32 s76, s73, 7
    v_cndmask_b32 v60, v60, v120, s[60:61]
    v_cndmask_b32 v61, v61, v120, s[60:61]
    v_cndmask_b32 v62, v62, v120, s[60:61]
    v_cndmask_b32 v63, v63, v120, s[60:61]
    s_nop 1
    v_mfma_f32_32x32x16_bf16 v[16:31], v[60:63], v[200:203], v[16:31]
    ds_read_b128 v[216:219], v8 offset:16384
    ds_read_b64_tr_b16 v[76:77], v251 offset:16384
    ds_read_b64_tr_b16 v[78:79], v251 offset:16640
    ds_read_b128 v[220:223], v10 offset:16384
    v_mfma_f32_4x4x4_16b_bf16 v[112:115], v[200:201], v[200:201], v[112:115]
    v_mfma_f32_4x4x4_16b_bf16 v[116:119], v[202:203], v[202:203], v[116:119]
    s_add_u32 m0, s51, 139264
    s_nop 0
    buffer_load_dwordx4 v124, s[24:27], s52 offen lds
    s_add_u32 m0, s51, 143360
    s_nop 0
    buffer_load_dwordx4 v125, s[24:27], s52 offen lds
    s_add_u32 s76, s76, 156672
    v_lshlrev_b32 v110, 2, v100
    v_add_u32 v106, s76, v110
    v_lshlrev_b32 v111, 2, v1
    v_add_u32 v107, 156672, v111
    s_waitcnt lgkmcnt(5)
    v_mfma_f32_32x32x16_bf16 v[16:31], v[68:71], v[208:211], v[16:31]
    ds_read_b128 v[224:227], v7 offset:16896
    ds_read_b64_tr_b16 v[84:85], v250 offset:18432
    ds_read_b64_tr_b16 v[86:87], v250 offset:18688
    ds_read_b128 v[228:231], v9 offset:16896
    v_mfma_f32_4x4x4_16b_bf16 v[112:115], v[208:209], v[208:209], v[112:115]
    v_mfma_f32_16x16x32_bf16 v[96:99], v[246:249], v[68:71], v[96:99]
    v_mfma_f32_4x4x4_16b_bf16 v[116:119], v[210:211], v[210:211], v[116:119]
    s_add_u32 m0, s51, 0
    s_nop 0
    buffer_load_dwordx4 v126, s[28:31], s53 offen lds
    s_add_u32 m0, s51, 4096
    s_nop 0
    buffer_load_dwordx4 v127, s[28:31], s53 offen lds
    s_lshl_b32 s76, s63, 7
    s_add_u32 s76, s76, 156928
    v_add_u32 v108, s76, v110
    s_lshl_b32 s76, s63, 11
    s_add_u32 s76, s76, 147456
    s_waitcnt lgkmcnt(5)
    s_waitcnt vmcnt(13)
    ds_write_b16 v121, v120 offset:40960
    v_mfma_f32_32x32x16_bf16 v[16:31], v[76:79], v[216:219], v[16:31]
    ds_read_b128 v[232:235], v8 offset:16896
    ds_read_b64_tr_b16 v[92:93], v251 offset:18432
    ds_read_b64_tr_b16 v[94:95], v251 offset:18688
    ds_read_b128 v[236:239], v10 offset:16896
    v_mfma_f32_4x4x4_16b_bf16 v[112:115], v[216:217], v[216:217], v[112:115]
    v_mfma_f32_4x4x4_16b_bf16 v[116:119], v[218:219], v[218:219], v[116:119]
    s_add_u32 m0, s51, 8192
    s_nop 0
    buffer_load_dwordx4 v5, s[28:31], s53 offen lds
    s_add_u32 s52, s52, 128
    s_add_u32 s53, s53, 172032
    s_cmp_eq_u32 s52, 896
    s_cselect_b32 s52, 0, s52
    s_cselect_b32 s53, 0, s53
    v_add_u32 v109, s76, v15
    s_bitcmp1_b32 s49, 0
    s_cselect_b32 s66, -1, 0
    s_mov_b32 s67, 0
    s_mov_b32 s68, 0
    s_cselect_b32 s69, 0, -1
    s_lshl_b32 s76, s48, 2
    s_add_u32 s76, s76, s63
    s_xor_b32 s77, s76, 1
    s_waitcnt vmcnt(14) lgkmcnt(0)
    s_barrier
    v_mfma_f32_32x32x16_bf16 v[16:31], v[84:87], v[224:227], v[16:31]
    ds_read_b128 v[32:35], v7 offset:32768
    ds_read_b64_tr_b16 v[36:37], v250 offset:32768
    ds_read_b64_tr_b16 v[38:39], v250 offset:33024
    v_mfma_f32_4x4x4_16b_bf16 v[112:115], v[224:225], v[224:225], v[112:115]
    v_mfma_f32_16x16x32_bf16 v[96:99], v[246:249], v[84:87], v[96:99]
    v_mfma_f32_4x4x4_16b_bf16 v[116:119], v[226:227], v[226:227], v[116:119]
    s_add_u32 m0, s51, 65536
    s_nop 0
    buffer_load_dwordx4 v4, s[24:27], s52 offen lds
    s_add_u32 m0, s51, 69632
    s_nop 0
    buffer_load_dwordx4 v123, s[24:27], s52 offen lds
    s_mul_i32 s78, s49, 7
    s_mul_i32 s70, s76, 112
    s_add_u32 s70, s70, s78
    s_add_u32 s72, s70, 3
    s_add_u32 s70, s70, s64
    v_mfma_f32_32x32x16_bf16 v[16:31], v[92:95], v[232:235], v[16:31]
    ds_read_b128 v[40:43], v8 offset:32768
    ds_read_b64_tr_b16 v[44:45], v251 offset:32768
    ds_read_b64_tr_b16 v[46:47], v251 offset:33024
    v_mfma_f32_4x4x4_16b_bf16 v[112:115], v[232:233], v[232:233], v[112:115]
    v_mfma_f32_4x4x4_16b_bf16 v[116:119], v[234:235], v[234:235], v[116:119]
    s_add_u32 m0, s51, 73728
    s_nop 0
    buffer_load_dwordx4 v124, s[24:27], s52 offen lds
    s_add_u32 m0, s51, 77824
    s_nop 0
    buffer_load_dwordx4 v125, s[24:27], s52 offen lds
    s_mul_i32 s71, s77, 112
    s_add_u32 s71, s71, s78
    s_add_u32 s71, s71, s64
    s_lshl_b32 s70, s70, 10
    s_add_u32 s70, s70, 6291456
    s_waitcnt lgkmcnt(3)
    v_mfma_f32_32x32x16_bf16 v[16:31], v[36:39], v[32:35], v[16:31]
    ds_read_b128 v[48:51], v7 offset:33280
    ds_read_b64_tr_b16 v[52:53], v250 offset:34816
    ds_read_b64_tr_b16 v[54:55], v250 offset:35072
    v_mfma_f32_4x4x4_16b_bf16 v[112:115], v[32:33], v[32:33], v[112:115]
    v_mfma_f32_16x16x32_bf16 v[96:99], v[246:249], v[36:39], v[96:99]
    v_mfma_f32_4x4x4_16b_bf16 v[116:119], v[34:35], v[34:35], v[116:119]
    s_add_u32 m0, s51, 16384
    s_nop 0
    buffer_load_dwordx4 v126, s[28:31], s53 offen lds
    s_add_u32 m0, s51, 20480
    s_nop 0
    buffer_load_dwordx4 v127, s[28:31], s53 offen lds
    s_lshl_b32 s71, s71, 10
    s_add_u32 s71, s71, 6291456
    s_lshl_b32 s72, s72, 10
    s_add_u32 s72, s72, 6291456
    s_mul_i32 s73, s99, 229376
    s_waitcnt lgkmcnt(3)
    s_waitcnt vmcnt(13)
    ds_write_b16 v121, v120 offset:57344
    v_mfma_f32_32x32x16_bf16 v[16:31], v[44:47], v[40:43], v[16:31]
    ds_read_b128 v[56:59], v8 offset:33280
    ds_read_b64_tr_b16 v[60:61], v251 offset:34816
    ds_read_b64_tr_b16 v[62:63], v251 offset:35072
    v_mfma_f32_4x4x4_16b_bf16 v[112:115], v[40:41], v[40:41], v[112:115]
    v_mfma_f32_4x4x4_16b_bf16 v[116:119], v[42:43], v[42:43], v[116:119]
    s_add_u32 m0, s51, 24576
    s_nop 0
    buffer_load_dwordx4 v5, s[28:31], s53 offen lds
    s_add_u32 s52, s52, 128
    s_add_u32 s53, s53, 172032
    s_cmp_eq_u32 s52, 896
    s_cselect_b32 s52, 0, s52
    s_cselect_b32 s53, 0, s53
    s_waitcnt vmcnt(14) lgkmcnt(0)
    s_barrier
    v_mfma_f32_32x32x16_bf16 v[16:31], v[52:55], v[48:51], v[16:31]
    ds_read_b128 v[64:67], v7 offset:49152
    ds_read_b64_tr_b16 v[68:69], v250 offset:49152
    ds_read_b64_tr_b16 v[70:71], v250 offset:49408
    v_mfma_f32_4x4x4_16b_bf16 v[112:115], v[48:49], v[48:49], v[112:115]
    v_mfma_f32_16x16x32_bf16 v[96:99], v[246:249], v[52:55], v[96:99]
    v_mfma_f32_4x4x4_16b_bf16 v[116:119], v[50:51], v[50:51], v[116:119]
    s_add_u32 m0, s51, 81920
    s_nop 0
    buffer_load_dwordx4 v4, s[24:27], s52 offen lds
    s_add_u32 m0, s51, 86016
    s_nop 0
    buffer_load_dwordx4 v123, s[24:27], s52 offen lds
    v_mfma_f32_32x32x16_bf16 v[16:31], v[60:63], v[56:59], v[16:31]
    ds_read_b128 v[72:75], v8 offset:49152
    ds_read_b64_tr_b16 v[76:77], v251 offset:49152
    ds_read_b64_tr_b16 v[78:79], v251 offset:49408
    v_mfma_f32_4x4x4_16b_bf16 v[112:115], v[56:57], v[56:57], v[112:115]
    v_mfma_f32_4x4x4_16b_bf16 v[116:119], v[58:59], v[58:59], v[116:119]
    s_add_u32 m0, s51, 90112
    s_nop 0
    buffer_load_dwordx4 v124, s[24:27], s52 offen lds
    s_add_u32 m0, s51, 94208
    s_nop 0
    buffer_load_dwordx4 v125, s[24:27], s52 offen lds
    s_waitcnt lgkmcnt(3)
    v_mfma_f32_32x32x16_bf16 v[16:31], v[68:71], v[64:67], v[16:31]
    ds_read_b128 v[80:83], v7 offset:49664
    ds_read_b64_tr_b16 v[84:85], v250 offset:51200
    ds_read_b64_tr_b16 v[86:87], v250 offset:51456
    v_mfma_f32_4x4x4_16b_bf16 v[112:115], v[64:65], v[64:65], v[112:115]
    v_mfma_f32_16x16x32_bf16 v[96:99], v[246:249], v[68:71], v[96:99]
    v_mfma_f32_4x4x4_16b_bf16 v[116:119], v[66:67], v[66:67], v[116:119]
    s_add_u32 m0, s51, 32768
    s_nop 0
    buffer_load_dwordx4 v126, s[28:31], s53 offen lds
    s_add_u32 m0, s51, 36864
    s_nop 0
    buffer_load_dwordx4 v127, s[28:31], s53 offen lds
    s_waitcnt lgkmcnt(3)
    s_waitcnt vmcnt(13)
    ds_write_b16 v121, v120 offset:8192
    v_mfma_f32_32x32x16_bf16 v[16:31], v[76:79], v[72:75], v[16:31]
    ds_read_b128 v[88:91], v8 offset:49664
    ds_read_b64_tr_b16 v[92:93], v251 offset:51200
    ds_read_b64_tr_b16 v[94:95], v251 offset:51456
    v_mfma_f32_4x4x4_16b_bf16 v[112:115], v[72:73], v[72:73], v[112:115]
    v_mfma_f32_4x4x4_16b_bf16 v[116:119], v[74:75], v[74:75], v[116:119]
    s_add_u32 m0, s51, 40960
    s_nop 0
    buffer_load_dwordx4 v5, s[28:31], s53 offen lds
    s_add_u32 s52, s52, 128
    s_add_u32 s53, s53, 172032
    s_cmp_eq_u32 s52, 896
    s_cselect_b32 s52, 0, s52
    s_cselect_b32 s53, 0, s53
    s_waitcnt vmcnt(14) lgkmcnt(0)
    s_barrier
    v_mfma_f32_32x32x16_bf16 v[16:31], v[84:87], v[80:83], v[16:31]
    ds_read_b128 v[32:35], v11 offset:0
    ds_read_b64_tr_b16 v[36:37], v250 offset:0
    ds_read_b64_tr_b16 v[38:39], v250 offset:256
    v_mfma_f32_4x4x4_16b_bf16 v[112:115], v[80:81], v[80:81], v[112:115]
    v_mfma_f32_16x16x32_bf16 v[96:99], v[246:249], v[84:87], v[96:99]
    v_mfma_f32_4x4x4_16b_bf16 v[116:119], v[82:83], v[82:83], v[116:119]
    s_add_u32 s74, s73, 57344
    s_add_u32 m0, s62, 49152
    s_nop 0
    buffer_load_dwordx4 v244, s[32:35], s73 offen lds
    v_mfma_f32_32x32x16_bf16 v[16:31], v[92:95], v[88:91], v[16:31]
    ds_read_b128 v[40:43], v12 offset:0
    ds_read_b64_tr_b16 v[44:45], v251 offset:0
    ds_read_b64_tr_b16 v[46:47], v251 offset:256
    v_mfma_f32_4x4x4_16b_bf16 v[112:115], v[88:89], v[88:89], v[112:115]
    v_mfma_f32_4x4x4_16b_bf16 v[116:119], v[90:91], v[90:91], v[116:119]
    s_add_u32 m0, s62, 53248
    s_nop 0
    buffer_load_dwordx4 v245, s[36:39], s73 offen lds
    s_waitcnt lgkmcnt(3)
    v_mfma_f32_32x32x16_bf16 v[16:31], v[36:39], v[32:35], v[16:31]
    ds_read_b128 v[48:51], v11 offset:512
    ds_read_b64_tr_b16 v[52:53], v250 offset:2048
    ds_read_b64_tr_b16 v[54:55], v250 offset:2304
    v_mfma_f32_4x4x4_16b_bf16 v[112:115], v[32:33], v[32:33], v[112:115]
    v_mfma_f32_16x16x32_bf16 v[96:99], v[246:249], v[36:39], v[96:99]
    v_mfma_f32_4x4x4_16b_bf16 v[116:119], v[34:35], v[34:35], v[116:119]
    s_add_u32 s73, s73, 114688
    s_cmp_eq_u32 s73, 1605632
    s_cselect_b32 s73, 0, s73
    s_add_u32 m0, s62, 57344
    s_nop 0
    buffer_load_dwordx4 v244, s[32:35], s74 offen lds
    s_waitcnt lgkmcnt(3)
    s_waitcnt vmcnt(10)
    ds_write_b16 v121, v120 offset:24576
    v_mfma_f32_32x32x16_bf16 v[16:31], v[44:47], v[40:43], v[16:31]
    ds_read_b128 v[56:59], v12 offset:512
    ds_read_b64_tr_b16 v[60:61], v251 offset:2048
    ds_read_b64_tr_b16 v[62:63], v251 offset:2304
    v_mfma_f32_4x4x4_16b_bf16 v[112:115], v[40:41], v[40:41], v[112:115]
    v_mfma_f32_4x4x4_16b_bf16 v[116:119], v[42:43], v[42:43], v[116:119]
    s_add_u32 m0, s62, 61440
    s_nop 0
    buffer_load_dwordx4 v245, s[36:39], s74 offen lds
    s_waitcnt vmcnt(11) lgkmcnt(0)
    s_barrier
    v_mfma_f32_32x32x16_bf16 v[16:31], v[52:55], v[48:51], v[16:31]
    ds_read_b128 v[64:67], v7 offset:0
    ds_read_b64_tr_b16 v[68:69], v250 offset:16384
    ds_read_b64_tr_b16 v[70:71], v250 offset:16640
    v_mfma_f32_4x4x4_16b_bf16 v[112:115], v[48:49], v[48:49], v[112:115]
    v_mfma_f32_16x16x32_bf16 v[96:99], v[246:249], v[52:55], v[96:99]
    v_mfma_f32_4x4x4_16b_bf16 v[116:119], v[50:51], v[50:51], v[116:119]
    s_add_u32 s74, s73, 57344
    s_add_u32 m0, s62, 0
    s_nop 0
    buffer_load_dwordx4 v244, s[32:35], s73 offen lds
    v_mfma_f32_32x32x16_bf16 v[16:31], v[60:63], v[56:59], v[16:31]
    ds_read_b128 v[72:75], v8 offset:0
    ds_read_b64_tr_b16 v[76:77], v251 offset:16384
    ds_read_b64_tr_b16 v[78:79], v251 offset:16640
    v_mfma_f32_4x4x4_16b_bf16 v[112:115], v[56:57], v[56:57], v[112:115]
    v_mfma_f32_4x4x4_16b_bf16 v[116:119], v[58:59], v[58:59], v[116:119]
    s_add_u32 m0, s62, 4096
    s_nop 0
    buffer_load_dwordx4 v245, s[36:39], s73 offen lds
    s_waitcnt lgkmcnt(3)
    v_mfma_f32_32x32x16_bf16 v[16:31], v[68:71], v[64:67], v[16:31]
    ds_read_b128 v[80:83], v7 offset:512
    ds_read_b64_tr_b16 v[84:85], v250 offset:18432
    ds_read_b64_tr_b16 v[86:87], v250 offset:18688
    v_mfma_f32_4x4x4_16b_bf16 v[112:115], v[64:65], v[64:65], v[112:115]
    v_mfma_f32_16x16x32_bf16 v[96:99], v[246:249], v[68:71], v[96:99]
    v_mfma_f32_4x4x4_16b_bf16 v[116:119], v[66:67], v[66:67], v[116:119]
    s_add_u32 s73, s73, 114688
    s_cmp_eq_u32 s73, 1605632
    s_cselect_b32 s73, 0, s73
    s_add_u32 m0, s62, 8192
    s_nop 0
    buffer_load_dwordx4 v244, s[32:35], s74 offen lds
    s_waitcnt lgkmcnt(3)
    s_waitcnt vmcnt(7)
    ds_write_b16 v121, v120 offset:40960
    v_mfma_f32_32x32x16_bf16 v[16:31], v[76:79], v[72:75], v[16:31]
    ds_read_b128 v[88:91], v8 offset:512
    ds_read_b64_tr_b16 v[92:93], v251 offset:18432
    ds_read_b64_tr_b16 v[94:95], v251 offset:18688
    v_mfma_f32_4x4x4_16b_bf16 v[112:115], v[72:73], v[72:73], v[112:115]
    v_mfma_f32_4x4x4_16b_bf16 v[116:119], v[74:75], v[74:75], v[116:119]
    s_add_u32 m0, s62, 12288
    s_nop 0
    buffer_load_dwordx4 v245, s[36:39], s74 offen lds
    s_waitcnt vmcnt(8) lgkmcnt(0)
    s_barrier
    v_mfma_f32_32x32x16_bf16 v[16:31], v[84:87], v[80:83], v[16:31]
    ds_read_b128 v[32:35], v7 offset:16384
    ds_read_b64_tr_b16 v[36:37], v250 offset:32768
    ds_read_b64_tr_b16 v[38:39], v250 offset:33024
    v_mfma_f32_4x4x4_16b_bf16 v[112:115], v[80:81], v[80:81], v[112:115]
    v_mfma_f32_16x16x32_bf16 v[96:99], v[246:249], v[84:87], v[96:99]
    v_mfma_f32_4x4x4_16b_bf16 v[116:119], v[82:83], v[82:83], v[116:119]
    s_add_u32 s74, s73, 57344
    s_add_u32 m0, s62, 16384
    s_nop 0
    buffer_load_dwordx4 v244, s[32:35], s73 offen lds
    v_mfma_f32_32x32x16_bf16 v[16:31], v[92:95], v[88:91], v[16:31]
    ds_read_b128 v[40:43], v8 offset:16384
    ds_read_b64_tr_b16 v[44:45], v251 offset:32768
    ds_read_b64_tr_b16 v[46:47], v251 offset:33024
    v_mfma_f32_4x4x4_16b_bf16 v[112:115], v[88:89], v[88:89], v[112:115]
    v_mfma_f32_4x4x4_16b_bf16 v[116:119], v[90:91], v[90:91], v[116:119]
    s_add_u32 m0, s62, 20480
    s_nop 0
    buffer_load_dwordx4 v245, s[36:39], s73 offen lds
    s_waitcnt lgkmcnt(3)
    v_mfma_f32_32x32x16_bf16 v[16:31], v[36:39], v[32:35], v[16:31]
    ds_read_b128 v[48:51], v7 offset:16896
    ds_read_b64_tr_b16 v[52:53], v250 offset:34816
    ds_read_b64_tr_b16 v[54:55], v250 offset:35072
    v_mfma_f32_4x4x4_16b_bf16 v[112:115], v[32:33], v[32:33], v[112:115]
    v_mfma_f32_16x16x32_bf16 v[96:99], v[246:249], v[36:39], v[96:99]
    v_mfma_f32_4x4x4_16b_bf16 v[116:119], v[34:35], v[34:35], v[116:119]
    s_add_u32 s73, s73, 114688
    s_cmp_eq_u32 s73, 1605632
    s_cselect_b32 s73, 0, s73
    s_add_u32 m0, s62, 24576
    s_nop 0
    buffer_load_dwordx4 v244, s[32:35], s74 offen lds
    s_waitcnt lgkmcnt(3)
    v_mfma_f32_32x32x16_bf16 v[16:31], v[44:47], v[40:43], v[16:31]
    ds_read_b128 v[56:59], v8 offset:16896
    ds_read_b64_tr_b16 v[60:61], v251 offset:34816
    ds_read_b64_tr_b16 v[62:63], v251 offset:35072
    v_mfma_f32_4x4x4_16b_bf16 v[112:115], v[40:41], v[40:41], v[112:115]
    v_mfma_f32_4x4x4_16b_bf16 v[116:119], v[42:43], v[42:43], v[116:119]
    s_add_u32 m0, s62, 28672
    s_nop 0
    buffer_load_dwordx4 v245, s[36:39], s74 offen lds
    s_waitcnt lgkmcnt(3)
    v_mfma_f32_32x32x16_bf16 v[16:31], v[52:55], v[48:51], v[16:31]
    v_mfma_f32_4x4x4_16b_bf16 v[112:115], v[48:49], v[48:49], v[112:115]
    v_mfma_f32_16x16x32_bf16 v[96:99], v[246:249], v[52:55], v[96:99]
    v_mfma_f32_4x4x4_16b_bf16 v[116:119], v[50:51], v[50:51], v[116:119]
    s_mov_b32 exec_hi, 0
    s_nop 5
    ds_write_b32 v106, v96 offset:0
    s_mov_b32 exec_hi, -1
    s_waitcnt lgkmcnt(1)
    v_mfma_f32_32x32x16_bf16 v[16:31], v[60:63], v[56:59], v[16:31]
    v_mfma_f32_4x4x4_16b_bf16 v[112:115], v[56:57], v[56:57], v[112:115]
    v_mfma_f32_4x4x4_16b_bf16 v[116:119], v[58:59], v[58:59], v[116:119]
    s_nop 4
    v_add_f32 v112, v112, v116
    v_add_f32 v113, v113, v117
    v_add_f32 v114, v114, v118
    v_add_f32 v115, v115, v119
    s_mov_b32 vcc_lo, 572662306
    s_mov_b32 vcc_hi, 572662306
    v_cndmask_b32 v112, v112, v113, vcc
    s_mov_b32 vcc_lo, 1145324612
    s_mov_b32 vcc_hi, 1145324612
    v_cndmask_b32 v112, v112, v114, vcc
    s_mov_b32 vcc_lo, 2290649224
    s_mov_b32 vcc_hi, 2290649224
    v_cndmask_b32 v112, v112, v115, vcc
    v_mov_b32 v118, 0
    v_mov_b32 v117, v112
    s_nop 1
    v_permlane32_swap_b32 v112, v117
    v_add_f32 v112, v112, v117
    v_cndmask_b32 v118, v118, v28, s[68:69]
    v_cndmask_b32 v118, v118, v16, s[66:67]
    v_mov_b32 v116, v118
    s_nop 1
    v_permlane32_swap_b32 v118, v116
    v_add_f32 v118, v118, v116
    v_mul_f32 v96, 0xbb124925, v118
    v_mul_f32 v116, 0x3b124925, v112
    v_fma_f32 v116, -v96, v96, v116
    v_max_f32 v116, 0, v116
    v_add_f32 v116, 0x3727c5ac, v116
    v_rsq_f32 v117, v116
    v_sqrt_f32 v118, v116
    ds_write_b32 v108, v96 offset:2816
    v_mul_f32 v119, 0xbfb8aa3b, v117
    ds_write_b32 v108, v117
    ds_write_b32 v108, v118 offset:3840
    ds_write_b32 v108, v119 offset:3328
    v_mul_f32 v98, 0x3e8b97f6, v117
    s_waitcnt vmcnt(8) lgkmcnt(0)
    s_barrier
    s_setprio 2
    ds_read_b32 v97, v107
    ds_read_b64_tr_b16 v[128:129], v240 offset:49152
    ds_read_b64_tr_b16 v[130:131], v240 offset:50176
    ds_read_b64_tr_b16 v[132:133], v240 offset:49184
    ds_read_b64_tr_b16 v[134:135], v240 offset:50208
    ds_read_b64_tr_b16 v[136:137], v240 offset:49216
    ds_read_b64_tr_b16 v[138:139], v240 offset:50240
    ds_read_b64_tr_b16 v[140:141], v242 offset:49152
    ds_read_b64_tr_b16 v[142:143], v242 offset:50176
    s_mov_b32 s24, s16
    s_mov_b32 s25, s17
    s_mov_b32 s26, 1605632
    s_mov_b32 s27, 0x20000
    s_mov_b32 s28, s8
    s_mov_b32 s29, s9
    s_mov_b32 s30, 401408
    s_mov_b32 s31, 0x20000
    s_waitcnt lgkmcnt(8)
    v_mfma_f32_32x32x2_f32 v[16:31], v97, v96, v[16:31]
    s_nop 15
    s_nop 3
    v_mul_f32 v16, v16, v98
    v_mul_f32 v17, v17, v98
    v_mul_f32 v18, v18, v98
    v_mul_f32 v19, v19, v98
    v_mul_f32 v20, v20, v98
    v_mul_f32 v21, v21, v98
    v_mul_f32 v22, v22, v98
    v_mul_f32 v23, v23, v98
    v_mul_f32 v24, v24, v98
    v_mul_f32 v25, v25, v98
    v_mul_f32 v26, v26, v98
    v_mul_f32 v27, v27, v98
    v_mul_f32 v28, v28, v98
    v_mul_f32 v29, v29, v98
    v_mul_f32 v30, v30, v98
    v_mul_f32 v31, v31, v98
    v_cvt_pk_bf16_f32 v80, v16, v17
    v_cvt_pk_bf16_f32 v81, v18, v19
    v_cvt_pk_bf16_f32 v82, v20, v21
    v_cvt_pk_bf16_f32 v83, v22, v23
    v_cvt_pk_bf16_f32 v84, v24, v25
    v_cvt_pk_bf16_f32 v85, v26, v27
    v_cvt_pk_bf16_f32 v86, v28, v29
    v_cvt_pk_bf16_f32 v87, v30, v31
    v_cndmask_b32 v80, v80, 0, s[66:67]
    v_cndmask_b32 v81, v81, 0, s[66:67]
    v_cndmask_b32 v86, v86, 0, s[68:69]
    v_cndmask_b32 v87, v87, 0, s[68:69]
    v_add_u32 v254, 2816, v108
    v_permlane32_swap_b32 v80, v82
    v_permlane32_swap_b32 v81, v83
    v_permlane32_swap_b32 v84, v86
    v_permlane32_swap_b32 v85, v87
    ds_write_b128 v109, v[80:83]
    ds_write_b128 v109, v[84:87] offset:1024
    ds_add_u32 v2, v3 offset:8
    s_lshl_b32 s75, s48, 2
    s_add_u32 s75, s75, s63
    s_lshl_b32 s75, s75, 4
    s_add_u32 s75, s75, s49
    s_lshl_b32 s75, s75, 11
    s_add_u32 s75, s75, 14680064
    v_mov_b32 v112, -1
    v_mov_b32 v113, -1
    v_mov_b32 v114, -1
    v_mov_b32 v115, -1
    buffer_store_dwordx4 v[112:115], v15, s[40:43], s75 offen offset:0 sc1
    buffer_store_dwordx4 v[112:115], v15, s[40:43], s75 offen offset:1024 sc1
    s_setprio 3
    s_waitcnt lgkmcnt(9)
    v_mfma_f32_32x32x16_bf16 v[16:31], v[128:131], v[176:179], 0
    ds_read_b64_tr_b16 v[144:145], v241 offset:49152
    ds_read_b64_tr_b16 v[146:147], v241 offset:50176
    s_waitcnt lgkmcnt(11)
    v_mfma_f32_32x32x16_bf16 v[32:47], v[128:131], v[180:183], 0
    ds_read_b64_tr_b16 v[148:149], v241 offset:49184
    ds_read_b64_tr_b16 v[150:151], v241 offset:50208
    v_mfma_f32_16x16x32_bf16 v[160:163], v[246:249], v[128:131], 0
    s_waitcnt lgkmcnt(11)
    v_mfma_f32_32x32x16_bf16 v[48:63], v[132:135], v[176:179], 0
    ds_read_b64_tr_b16 v[152:153], v241 offset:49216
    ds_read_b64_tr_b16 v[154:155], v241 offset:50240
    s_waitcnt lgkmcnt(13)
    v_mfma_f32_32x32x16_bf16 v[64:79], v[132:135], v[180:183], 0
    ds_read_b64_tr_b16 v[156:157], v243 offset:49152
    ds_read_b64_tr_b16 v[158:159], v243 offset:50176
    v_mfma_f32_16x16x32_bf16 v[164:167], v[246:249], v[132:135], 0
    s_waitcnt lgkmcnt(13)
    v_mfma_f32_32x32x16_bf16 v[80:95], v[136:139], v[176:179], 0
    s_waitcnt vmcnt(6)
    ds_add_u32 v2, v3 offset:36
    s_waitcnt lgkmcnt(14)
    v_mfma_f32_32x32x16_bf16 v[96:111], v[136:139], v[180:183], 0
    v_mfma_f32_16x16x32_bf16 v[168:171], v[246:249], v[136:139], 0
    s_waitcnt lgkmcnt(12)
    v_mfma_f32_32x32x16_bf16 v[112:127], v[140:143], v[176:179], 0
    v_mfma_f32_16x16x32_bf16 v[172:175], v[246:249], v[140:143], 0
    ds_read_b32 v252, v6 offset:36
    s_waitcnt lgkmcnt(8)
    v_mfma_f32_32x32x16_bf16 v[16:31], v[144:147], v[184:187], v[16:31]
    s_waitcnt lgkmcnt(0)
    v_readfirstlane_b32 s97, v252
    s_nop 1
    s_cmp_ge_u32 s97, 4
    s_cbranch_scc1 ok_19
    s_mov_b32 s96, 0
sw_20:
    ds_read_b32 v252, v6 offset:36
    s_add_u32 s96, s96, 1
    s_waitcnt lgkmcnt(0)
    v_readfirstlane_b32 s97, v252
    s_nop 1
    s_cmp_ge_u32 s97, 4
    s_cbranch_scc1 ok_19
    s_cmp_ge_u32 s96, 160000
    s_cbranch_scc1 ok_19
    s_sleep 1
    s_branch sw_20
ok_19:
    ds_read_b64_tr_b16 v[128:129], v240 offset:0
    ds_read_b64_tr_b16 v[130:131], v240 offset:1024
    s_mul_i32 s6, s54, 37
    s_waitcnt lgkmcnt(10)
    v_mfma_f32_32x32x16_bf16 v[32:47], v[144:147], v[188:191], v[32:47]
    ds_read_b64_tr_b16 v[132:133], v240 offset:32
    ds_read_b64_tr_b16 v[134:135], v240 offset:1056
    s_lshr_b32 s6, s6, 8
    s_waitcnt lgkmcnt(10)
    v_mfma_f32_32x32x16_bf16 v[48:63], v[148:151], v[184:187], v[48:63]
    ds_read_b64_tr_b16 v[136:137], v240 offset:64
    ds_read_b64_tr_b16 v[138:139], v240 offset:1088
    s_mul_i32 s7, s6, 7
    s_waitcnt lgkmcnt(12)
    v_mfma_f32_32x32x16_bf16 v[64:79], v[148:151], v[188:191], v[64:79]
    s_add_u32 s74, s73, 57344
    s_add_u32 m0, s62, 32768
    s_nop 0
    buffer_load_dwordx4 v244, s[32:35], s73 offen lds
    ds_read_b64_tr_b16 v[140:141], v242 offset:0
    ds_read_b64_tr_b16 v[142:143], v242 offset:1024
    s_sub_u32 s7, s54, s7
    s_waitcnt lgkmcnt(12)
    v_mfma_f32_32x32x16_bf16 v[80:95], v[152:155], v[184:187], v[80:95]
    s_add_u32 m0, s62, 36864
    s_nop 0
    buffer_load_dwordx4 v245, s[36:39], s73 offen lds
    s_and_b32 s78, s98, 1
    s_waitcnt lgkmcnt(12)
    v_mfma_f32_32x32x16_bf16 v[96:111], v[152:155], v[188:191], v[96:111]
    s_add_u32 s73, s73, 114688
    s_cmp_eq_u32 s73, 1605632
    s_cselect_b32 s73, 0, s73
    s_add_u32 m0, s62, 40960
    s_nop 0
    buffer_load_dwordx4 v244, s[32:35], s74 offen lds
    s_lshl_b32 s78, s78, 4
    s_waitcnt lgkmcnt(10)
    v_mfma_f32_32x32x16_bf16 v[112:127], v[156:159], v[184:187], v[112:127]
    s_add_u32 m0, s62, 45056
    s_nop 0
    buffer_load_dwordx4 v245, s[36:39], s74 offen lds
    s_add_u32 s6, s6, s78
    s_waitcnt lgkmcnt(6)
    v_mfma_f32_32x32x16_bf16 v[16:31], v[128:131], v[192:195], v[16:31]
    ds_read_b64_tr_b16 v[144:145], v241 offset:0
    ds_read_b64_tr_b16 v[146:147], v241 offset:1024
    s_lshr_b32 s78, s98, 1
    s_waitcnt lgkmcnt(8)
    v_mfma_f32_32x32x16_bf16 v[32:47], v[128:131], v[196:199], v[32:47]
    ds_read_b64_tr_b16 v[148:149], v241 offset:32
    ds_read_b64_tr_b16 v[150:151], v241 offset:1056
    v_mfma_f32_16x16x32_bf16 v[176:179], v[246:249], v[128:131], v[160:163]
    s_lshl_b32 s78, s78, 2
    s_waitcnt lgkmcnt(8)
    v_mfma_f32_32x32x16_bf16 v[48:63], v[132:135], v[192:195], v[48:63]
    ds_read_b64_tr_b16 v[152:153], v241 offset:64
    ds_read_b64_tr_b16 v[154:155], v241 offset:1088
    s_add_u32 s6, s6, s78
    s_waitcnt lgkmcnt(10)
    v_mfma_f32_32x32x16_bf16 v[64:79], v[132:135], v[196:199], v[64:79]
    ds_read_b64_tr_b16 v[156:157], v243 offset:0
    ds_read_b64_tr_b16 v[158:159], v243 offset:1024
    v_mfma_f32_16x16x32_bf16 v[180:183], v[246:249], v[132:135], v[164:167]
    s_mul_i32 s15, s58, 12288
    s_waitcnt lgkmcnt(10)
    v_mfma_f32_32x32x16_bf16 v[80:95], v[136:139], v[192:195], v[80:95]
    s_waitcnt vmcnt(6)
    ds_add_u32 v2, v3 offset:40
    s_add_u32 s15, s15, 110592
    s_waitcnt lgkmcnt(11)
    v_mfma_f32_32x32x16_bf16 v[96:111], v[136:139], v[196:199], v[96:111]
    v_mfma_f32_16x16x32_bf16 v[184:187], v[246:249], v[136:139], v[168:171]
    s_mul_i32 s20, s58, 15360
    s_waitcnt lgkmcnt(9)
    v_mfma_f32_32x32x16_bf16 v[112:127], v[140:143], v[192:195], v[112:127]
    v_mfma_f32_16x16x32_bf16 v[188:191], v[246:249], v[140:143], v[172:175]
    ds_read_b32 v252, v6 offset:40
    s_add_u32 s20, s20, 49152
    s_waitcnt lgkmcnt(8)
    v_mfma_f32_32x32x16_bf16 v[16:31], v[144:147], v[200:203], v[16:31]
    s_waitcnt lgkmcnt(0)
    v_readfirstlane_b32 s97, v252
    s_nop 1
    s_cmp_ge_u32 s97, 4
    s_cbranch_scc1 ok_21
    s_mov_b32 s96, 0
sw_22:
    ds_read_b32 v252, v6 offset:40
    s_add_u32 s96, s96, 1
    s_waitcnt lgkmcnt(0)
    v_readfirstlane_b32 s97, v252
    s_nop 1
    s_cmp_ge_u32 s97, 4
    s_cbranch_scc1 ok_21
    s_cmp_ge_u32 s96, 160000
    s_cbranch_scc1 ok_21
    s_sleep 1
    s_branch sw_22
ok_21:
    ds_read_b64_tr_b16 v[128:129], v240 offset:16384
    ds_read_b64_tr_b16 v[130:131], v240 offset:17408
    s_mul_i32 s11, s58, 401408
    s_waitcnt lgkmcnt(10)
    v_mfma_f32_32x32x16_bf16 v[32:47], v[144:147], v[204:207], v[32:47]
    ds_read_b64_tr_b16 v[132:133], v240 offset:16416
    ds_read_b64_tr_b16 v[134:135], v240 offset:17440
    s_and_b32 s76, s58, 1
    s_waitcnt lgkmcnt(10)
    v_mfma_f32_32x32x16_bf16 v[48:63], v[148:151], v[200:203], v[48:63]
    ds_read_b64_tr_b16 v[136:137], v240 offset:16448
    ds_read_b64_tr_b16 v[138:139], v240 offset:17472
    s_lshl_b32 s10, s6, 1
    s_waitcnt lgkmcnt(12)
    v_mfma_f32_32x32x16_bf16 v[64:79], v[148:151], v[204:207], v[64:79]
    s_add_u32 s74, s73, 57344
    s_add_u32 m0, s62, 49152
    s_nop 0
    buffer_load_dwordx4 v244, s[32:35], s73 offen lds
    ds_read_b64_tr_b16 v[140:141], v242 offset:16384
    ds_read_b64_tr_b16 v[142:143], v242 offset:17408
    s_add_u32 s10, s10, s76
    s_waitcnt lgkmcnt(12)
    v_mfma_f32_32x32x16_bf16 v[80:95], v[152:155], v[200:203], v[80:95]
    s_add_u32 m0, s62, 53248
    s_nop 0
    buffer_load_dwordx4 v245, s[36:39], s73 offen lds
    s_mul_i32 s14, s10, 28672
    s_waitcnt lgkmcnt(12)
    v_mfma_f32_32x32x16_bf16 v[96:111], v[152:155], v[204:207], v[96:111]
    s_add_u32 s73, s73, 114688
    s_cmp_eq_u32 s73, 1605632
    s_cselect_b32 s73, 0, s73
    s_add_u32 m0, s62, 57344
    s_nop 0
    buffer_load_dwordx4 v244, s[32:35], s74 offen lds
    s_lshl_b32 s78, s7, 7
    s_waitcnt lgkmcnt(10)
    v_mfma_f32_32x32x16_bf16 v[112:127], v[156:159], v[200:203], v[112:127]
    s_add_u32 m0, s62, 61440
    s_nop 0
    buffer_load_dwordx4 v245, s[36:39], s74 offen lds
    s_add_u32 s14, s14, s78
    s_waitcnt lgkmcnt(6)
    v_mfma_f32_32x32x16_bf16 v[16:31], v[128:131], v[208:211], v[16:31]
    ds_read_b64_tr_b16 v[144:145], v241 offset:16384
    ds_read_b64_tr_b16 v[146:147], v241 offset:17408
    s_lshr_b32 s79, s58, 1
    s_waitcnt lgkmcnt(8)
    v_mfma_f32_32x32x16_bf16 v[32:47], v[128:131], v[212:215], v[32:47]
    ds_read_b64_tr_b16 v[148:149], v241 offset:16416
    ds_read_b64_tr_b16 v[150:151], v241 offset:17440
    v_mfma_f32_16x16x32_bf16 v[176:179], v[246:249], v[128:131], v[176:179]
    s_lshl_b32 s77, s79, 6
    s_waitcnt lgkmcnt(8)
    v_mfma_f32_32x32x16_bf16 v[48:63], v[132:135], v[208:211], v[48:63]
    ds_read_b64_tr_b16 v[152:153], v241 offset:16448
    ds_read_b64_tr_b16 v[154:155], v241 offset:17472
    s_add_u32 s14, s14, s77
    s_waitcnt lgkmcnt(10)
    v_mfma_f32_32x32x16_bf16 v[64:79], v[132:135], v[212:215], v[64:79]
    ds_read_b64_tr_b16 v[156:157], v243 offset:16384
    ds_read_b64_tr_b16 v[158:159], v243 offset:17408
    v_mfma_f32_16x16x32_bf16 v[180:183], v[246:249], v[132:135], v[180:183]
    s_lshl_b32 s21, s48, 1
    s_waitcnt lgkmcnt(10)
    v_mfma_f32_32x32x16_bf16 v[80:95], v[136:139], v[208:211], v[80:95]
    s_waitcnt vmcnt(4)
    ds_add_u32 v2, v3 offset:44
    s_add_u32 s21, s21, s76
    s_waitcnt lgkmcnt(11)
    v_mfma_f32_32x32x16_bf16 v[96:111], v[136:139], v[212:215], v[96:111]
    v_mfma_f32_16x16x32_bf16 v[184:187], v[246:249], v[136:139], v[184:187]
    s_lshl_b32 s21, s21, 4
    s_waitcnt lgkmcnt(9)
    v_mfma_f32_32x32x16_bf16 v[112:127], v[140:143], v[208:211], v[112:127]
    v_mfma_f32_16x16x32_bf16 v[188:191], v[246:249], v[140:143], v[188:191]
    ds_read_b32 v252, v6 offset:44
    s_add_u32 s21, s21, s49
    s_waitcnt lgkmcnt(8)
    v_mfma_f32_32x32x16_bf16 v[16:31], v[144:147], v[216:219], v[16:31]
    s_waitcnt lgkmcnt(0)
    v_readfirstlane_b32 s97, v252
    s_nop 1
    s_cmp_ge_u32 s97, 4
    s_cbranch_scc1 ok_23
    s_mov_b32 s96, 0
sw_24:
    ds_read_b32 v252, v6 offset:44
    s_add_u32 s96, s96, 1
    s_waitcnt lgkmcnt(0)
    v_readfirstlane_b32 s97, v252
    s_nop 1
    s_cmp_ge_u32 s97, 4
    s_cbranch_scc1 ok_23
    s_cmp_ge_u32 s96, 160000
    s_cbranch_scc1 ok_23
    s_sleep 1
    s_branch sw_24
ok_23:
    ds_read_b64_tr_b16 v[128:129], v240 offset:32768
    ds_read_b64_tr_b16 v[130:131], v240 offset:33792
    s_lshl_b32 s21, s21, 1
    s_waitcnt lgkmcnt(10)
    v_mfma_f32_32x32x16_bf16 v[32:47], v[144:147], v[220:223], v[32:47]
    ds_read_b64_tr_b16 v[132:133], v240 offset:32800
    ds_read_b64_tr_b16 v[134:135], v240 offset:33824
    s_add_u32 s21, s21, s79
    s_waitcnt lgkmcnt(10)
    v_mfma_f32_32x32x16_bf16 v[48:63], v[148:151], v[216:219], v[48:63]
    ds_read_b64_tr_b16 v[136:137], v240 offset:32832
    ds_read_b64_tr_b16 v[138:139], v240 offset:33856
    s_lshl_b32 s21, s21, 2
    s_waitcnt lgkmcnt(12)
    v_mfma_f32_32x32x16_bf16 v[64:79], v[148:151], v[220:223], v[64:79]
    s_add_u32 s74, s73, 57344
    s_add_u32 m0, s62, 0
    s_nop 0
    buffer_load_dwordx4 v244, s[32:35], s73 offen lds
    ds_read_b64_tr_b16 v[140:141], v242 offset:32768
    ds_read_b64_tr_b16 v[142:143], v242 offset:33792
    s_andn2_b32 s77, s21, 31
    s_waitcnt lgkmcnt(12)
    v_mfma_f32_32x32x16_bf16 v[80:95], v[152:155], v[216:219], v[80:95]
    s_add_u32 m0, s62, 4096
    s_nop 0
    buffer_load_dwordx4 v245, s[36:39], s73 offen lds
    s_mul_i32 s77, s77, 3
    s_waitcnt lgkmcnt(12)
    v_mfma_f32_32x32x16_bf16 v[96:111], v[152:155], v[220:223], v[96:111]
    s_add_u32 s73, s73, 114688
    s_cmp_eq_u32 s73, 1605632
    s_cselect_b32 s73, 0, s73
    s_add_u32 m0, s62, 8192
    s_nop 0
    buffer_load_dwordx4 v244, s[32:35], s74 offen lds
    s_add_u32 s21, s21, s77
    s_waitcnt lgkmcnt(10)
    v_mfma_f32_32x32x16_bf16 v[112:127], v[156:159], v[216:219], v[112:127]
    s_add_u32 m0, s62, 12288
    s_nop 0
    buffer_load_dwordx4 v245, s[36:39], s74 offen lds
    s_add_u32 s21, s21, 16908288
    s_waitcnt lgkmcnt(6)
    v_mfma_f32_32x32x16_bf16 v[16:31], v[128:131], v[224:227], v[16:31]
    ds_read_b64_tr_b16 v[144:145], v241 offset:32768
    ds_read_b64_tr_b16 v[146:147], v241 offset:33792
    s_lshl_b32 s22, s7, 5
    s_waitcnt lgkmcnt(8)
    v_mfma_f32_32x32x16_bf16 v[32:47], v[128:131], v[228:231], v[32:47]
    ds_read_b64_tr_b16 v[148:149], v241 offset:32800
    ds_read_b64_tr_b16 v[150:151], v241 offset:33824
    v_mfma_f32_16x16x32_bf16 v[176:179], v[246:249], v[128:131], v[176:179]
    s_add_u32 s22, s22, s6
    s_waitcnt lgkmcnt(8)
    v_mfma_f32_32x32x16_bf16 v[48:63], v[132:135], v[224:227], v[48:63]
    ds_read_b64_tr_b16 v[152:153], v241 offset:32832
    ds_read_b64_tr_b16 v[154:155], v241 offset:33856
    s_lshl_b32 s22, s22, 2
    s_waitcnt lgkmcnt(10)
    v_mfma_f32_32x32x16_bf16 v[64:79], v[132:135], v[228:231], v[64:79]
    ds_read_b64_tr_b16 v[156:157], v243 offset:32768
    ds_read_b64_tr_b16 v[158:159], v243 offset:33792
    v_mfma_f32_16x16x32_bf16 v[180:183], v[246:249], v[132:135], v[180:183]
    s_add_u32 s22, s22, s58
    s_waitcnt lgkmcnt(10)
    v_mfma_f32_32x32x16_bf16 v[80:95], v[136:139], v[224:227], v[80:95]
    s_waitcnt vmcnt(4)
    ds_add_u32 v2, v3 offset:48
    s_lshl_b32 s22, s22, 7
    s_waitcnt lgkmcnt(11)
    v_mfma_f32_32x32x16_bf16 v[96:111], v[136:139], v[228:231], v[96:111]
    v_mfma_f32_16x16x32_bf16 v[184:187], v[246:249], v[136:139], v[184:187]
    s_add_u32 s22, s22, 16908288
    s_waitcnt lgkmcnt(9)
    v_mfma_f32_32x32x16_bf16 v[112:127], v[140:143], v[224:227], v[112:127]
    v_mfma_f32_16x16x32_bf16 v[188:191], v[246:249], v[140:143], v[188:191]
    ds_read_b32 v252, v6 offset:48
    s_mul_i32 s12, s10, 112
    s_waitcnt lgkmcnt(8)
    v_mfma_f32_32x32x16_bf16 v[16:31], v[144:147], v[232:235], v[16:31]
    s_waitcnt lgkmcnt(0)
    v_readfirstlane_b32 s97, v252
    s_nop 1
    s_cmp_ge_u32 s97, 4
    s_cbranch_scc1 ok_25
    s_mov_b32 s96, 0
sw_26:
    ds_read_b32 v252, v6 offset:48
    s_add_u32 s96, s96, 1
    s_waitcnt lgkmcnt(0)
    v_readfirstlane_b32 s97, v252
    s_nop 1
    s_cmp_ge_u32 s97, 4
    s_cbranch_scc1 ok_25
    s_cmp_ge_u32 s96, 160000
    s_cbranch_scc1 ok_25
    s_sleep 1
    s_branch sw_26
ok_25:
    ds_read_b128 v[160:163], v7 offset:32768
    ds_read_b64_tr_b16 v[128:129], v240 offset:49152
    s_mul_i32 s77, s58, 28
    s_waitcnt lgkmcnt(10)
    v_mfma_f32_32x32x16_bf16 v[32:47], v[144:147], v[236:239], v[32:47]
    ds_read_b64_tr_b16 v[130:131], v240 offset:50176
    ds_read_b128 v[164:167], v9 offset:32768
    s_add_u32 s12, s12, s77
    s_waitcnt lgkmcnt(10)
    v_mfma_f32_32x32x16_bf16 v[48:63], v[148:151], v[232:235], v[48:63]
    ds_read_b64_tr_b16 v[132:133], v240 offset:49184
    ds_read_b64_tr_b16 v[134:135], v240 offset:50208
    s_lshl_b32 s12, s12, 10
    s_waitcnt lgkmcnt(12)
    v_mfma_f32_32x32x16_bf16 v[64:79], v[148:151], v[236:239], v[64:79]
    s_add_u32 s74, s73, 57344
    s_add_u32 m0, s62, 16384
    s_nop 0
    buffer_load_dwordx4 v244, s[32:35], s73 offen lds
    ds_read_b64_tr_b16 v[136:137], v240 offset:49216
    ds_read_b64_tr_b16 v[138:139], v240 offset:50240
    s_add_u32 s12, s12, 6291456
    s_waitcnt lgkmcnt(12)
    v_mfma_f32_32x32x16_bf16 v[80:95], v[152:155], v[232:235], v[80:95]
    s_add_u32 m0, s62, 20480
    s_nop 0
    buffer_load_dwordx4 v245, s[36:39], s73 offen lds
    ds_read_b64_tr_b16 v[140:141], v242 offset:49152
    ds_read_b64_tr_b16 v[142:143], v242 offset:50176
    s_xor_b32 s13, s10, 1
    s_waitcnt lgkmcnt(14)
    v_mfma_f32_32x32x16_bf16 v[96:111], v[152:155], v[236:239], v[96:111]
    s_add_u32 s73, s73, 114688
    s_cmp_eq_u32 s73, 1605632
    s_cselect_b32 s73, 0, s73
    s_add_u32 m0, s62, 24576
    s_nop 0
    buffer_load_dwordx4 v244, s[32:35], s74 offen lds
    s_mul_i32 s13, s13, 112
    s_waitcnt lgkmcnt(12)
    v_mfma_f32_32x32x16_bf16 v[112:127], v[156:159], v[232:235], v[112:127]
    s_add_u32 m0, s62, 28672
    s_nop 0
    buffer_load_dwordx4 v245, s[36:39], s74 offen lds
    s_add_u32 s13, s13, s77
    s_waitcnt lgkmcnt(7)
    v_mfma_f32_32x32x16_bf16 v[16:31], v[128:131], v[160:163], v[16:31]
    ds_read_b128 v[168:171], v8 offset:32768
    ds_read_b64_tr_b16 v[144:145], v241 offset:49152
    s_lshl_b32 s13, s13, 10
    s_waitcnt lgkmcnt(8)
    v_mfma_f32_32x32x16_bf16 v[32:47], v[128:131], v[164:167], v[32:47]
    ds_read_b64_tr_b16 v[146:147], v241 offset:50176
    ds_read_b128 v[172:175], v10 offset:32768
    v_mfma_f32_16x16x32_bf16 v[176:179], v[246:249], v[128:131], v[176:179]
    s_add_u32 s13, s13, 6291456
    s_waitcnt lgkmcnt(8)
    v_mfma_f32_32x32x16_bf16 v[48:63], v[132:135], v[160:163], v[48:63]
    ds_read_b64_tr_b16 v[148:149], v241 offset:49184
    ds_read_b64_tr_b16 v[150:151], v241 offset:50208
    s_min_u32 s23, s12, s13
    s_waitcnt lgkmcnt(10)
    v_mfma_f32_32x32x16_bf16 v[64:79], v[132:135], v[164:167], v[64:79]
    ds_read_b64_tr_b16 v[152:153], v241 offset:49216
    ds_read_b64_tr_b16 v[154:155], v241 offset:50240
    v_mfma_f32_16x16x32_bf16 v[180:183], v[246:249], v[132:135], v[180:183]
    s_waitcnt lgkmcnt(10)
    v_mfma_f32_32x32x16_bf16 v[80:95], v[136:139], v[160:163], v[80:95]
    ds_read_b64_tr_b16 v[156:157], v243 offset:49152
    ds_read_b64_tr_b16 v[158:159], v243 offset:50176
    s_waitcnt vmcnt(4)
    ds_add_u32 v2, v3 offset:52
    s_lshl_b32 s77, s7, 12
    s_waitcnt lgkmcnt(13)
    v_mfma_f32_32x32x16_bf16 v[96:111], v[136:139], v[164:167], v[96:111]
    v_mfma_f32_16x16x32_bf16 v[184:187], v[246:249], v[136:139], v[184:187]
    s_add_u32 s23, s23, s77
    s_waitcnt lgkmcnt(11)
    v_mfma_f32_32x32x16_bf16 v[112:127], v[140:143], v[160:163], v[112:127]
    v_mfma_f32_16x16x32_bf16 v[188:191], v[246:249], v[140:143], v[188:191]
    ds_read_b32 v252, v6 offset:52
    s_waitcnt lgkmcnt(9)
    v_mfma_f32_32x32x16_bf16 v[16:31], v[144:147], v[168:171], v[16:31]
    s_waitcnt lgkmcnt(0)
    v_readfirstlane_b32 s97, v252
    s_nop 1
    s_cmp_ge_u32 s97, 4
    s_cbranch_scc1 ok_27
    s_mov_b32 s96, 0
sw_28:
    ds_read_b32 v252, v6 offset:52
    s_add_u32 s96, s96, 1
    s_waitcnt lgkmcnt(0)
    v_readfirstlane_b32 s97, v252
    s_nop 1
    s_cmp_ge_u32 s97, 4
    s_cbranch_scc1 ok_27
    s_cmp_ge_u32 s96, 160000
    s_cbranch_scc1 ok_27
    s_sleep 1
    s_branch sw_28
ok_27:
    ds_read_b128 v[160:163], v7 offset:33280
    ds_read_b64_tr_b16 v[128:129], v240 offset:0
    s_waitcnt lgkmcnt(10)
    v_mfma_f32_32x32x16_bf16 v[32:47], v[144:147], v[172:175], v[32:47]
    ds_read_b64_tr_b16 v[130:131], v240 offset:1024
    ds_read_b128 v[164:167], v9 offset:33280
    s_waitcnt lgkmcnt(10)
    v_mfma_f32_32x32x16_bf16 v[48:63], v[148:151], v[168:171], v[48:63]
    ds_read_b64_tr_b16 v[132:133], v240 offset:32
    ds_read_b64_tr_b16 v[134:135], v240 offset:1056
    s_waitcnt lgkmcnt(12)
    v_mfma_f32_32x32x16_bf16 v[64:79], v[148:151], v[172:175], v[64:79]
    s_add_u32 s74, s73, 57344
    s_add_u32 m0, s62, 32768
    s_nop 0
    buffer_load_dwordx4 v244, s[32:35], s73 offen lds
    ds_read_b64_tr_b16 v[136:137], v240 offset:64
    ds_read_b64_tr_b16 v[138:139], v240 offset:1088
    s_waitcnt lgkmcnt(12)
    v_mfma_f32_32x32x16_bf16 v[80:95], v[152:155], v[168:171], v[80:95]
    s_add_u32 m0, s62, 36864
    s_nop 0
    buffer_load_dwordx4 v245, s[36:39], s73 offen lds
    ds_read_b64_tr_b16 v[140:141], v242 offset:0
    ds_read_b64_tr_b16 v[142:143], v242 offset:1024
    s_waitcnt lgkmcnt(14)
    v_mfma_f32_32x32x16_bf16 v[96:111], v[152:155], v[172:175], v[96:111]
    s_add_u32 s73, s73, 114688
    s_cmp_eq_u32 s73, 1605632
    s_cselect_b32 s73, 0, s73
    s_add_u32 m0, s62, 40960
    s_nop 0
    buffer_load_dwordx4 v244, s[32:35], s74 offen lds
    s_waitcnt lgkmcnt(12)
    v_mfma_f32_32x32x16_bf16 v[112:127], v[156:159], v[168:171], v[112:127]
    s_add_u32 m0, s62, 45056
    s_nop 0
    buffer_load_dwordx4 v245, s[36:39], s74 offen lds
    s_waitcnt lgkmcnt(7)
    v_mfma_f32_32x32x16_bf16 v[16:31], v[128:131], v[160:163], v[16:31]
    ds_read_b128 v[168:171], v8 offset:33280
    ds_read_b64_tr_b16 v[144:145], v241 offset:0
    v_and_b32 v220, 31, v1
    s_waitcnt lgkmcnt(8)
    v_mfma_f32_32x32x16_bf16 v[32:47], v[128:131], v[164:167], v[32:47]
    ds_read_b64_tr_b16 v[146:147], v241 offset:1024
    ds_read_b128 v[172:175], v10 offset:33280
    v_mfma_f32_16x16x32_bf16 v[176:179], v[246:249], v[128:131], v[176:179]
    v_lshlrev_b32 v220, 2, v220
    s_waitcnt lgkmcnt(8)
    v_mfma_f32_32x32x16_bf16 v[48:63], v[132:135], v[160:163], v[48:63]
    ds_read_b64_tr_b16 v[148:149], v241 offset:32
    ds_read_b64_tr_b16 v[150:151], v241 offset:1056
    s_lshl_b32 s75, s64, 8
    s_waitcnt lgkmcnt(10)
    v_mfma_f32_32x32x16_bf16 v[64:79], v[132:135], v[164:167], v[64:79]
    ds_read_b64_tr_b16 v[152:153], v241 offset:64
    ds_read_b64_tr_b16 v[154:155], v241 offset:1088
    v_mfma_f32_16x16x32_bf16 v[180:183], v[246:249], v[132:135], v[180:183]
    s_add_u32 s75, s75, 161280
    s_waitcnt lgkmcnt(10)
    v_mfma_f32_32x32x16_bf16 v[80:95], v[136:139], v[160:163], v[80:95]
    ds_read_b64_tr_b16 v[156:157], v243 offset:0
    ds_read_b64_tr_b16 v[158:159], v243 offset:1024
    s_waitcnt vmcnt(4)
    ds_add_u32 v2, v3 offset:56
    s_and_b32 s76, s58, 1
    s_waitcnt lgkmcnt(13)
    v_mfma_f32_32x32x16_bf16 v[96:111], v[136:139], v[164:167], v[96:111]
    v_mfma_f32_16x16x32_bf16 v[184:187], v[246:249], v[136:139], v[184:187]
    v_lshl_add_u32 v221, s76, 7, v220
    s_waitcnt lgkmcnt(11)
    v_mfma_f32_32x32x16_bf16 v[112:127], v[140:143], v[160:163], v[112:127]
    v_mfma_f32_16x16x32_bf16 v[188:191], v[246:249], v[140:143], v[188:191]
    ds_read_b32 v252, v6 offset:56
    s_waitcnt lgkmcnt(9)
    v_mfma_f32_32x32x16_bf16 v[16:31], v[144:147], v[168:171], v[16:31]
    s_waitcnt lgkmcnt(0)
    v_readfirstlane_b32 s97, v252
    s_nop 1
    s_cmp_ge_u32 s97, 4
    s_cbranch_scc1 ok_29
    s_mov_b32 s96, 0
sw_30:
    ds_read_b32 v252, v6 offset:56
    s_add_u32 s96, s96, 1
    s_waitcnt lgkmcnt(0)
    v_readfirstlane_b32 s97, v252
    s_nop 1
    s_cmp_ge_u32 s97, 4
    s_cbranch_scc1 ok_29
    s_cmp_ge_u32 s96, 160000
    s_cbranch_scc1 ok_29
    s_sleep 1
    s_branch sw_30
ok_29:
    ds_read_b128 v[160:163], v7 offset:49152
    ds_read_b64_tr_b16 v[128:129], v240 offset:16384
    v_add_u32 v195, s75, v221
    s_waitcnt lgkmcnt(10)
    v_mfma_f32_32x32x16_bf16 v[32:47], v[144:147], v[172:175], v[32:47]
    ds_read_b64_tr_b16 v[130:131], v240 offset:17408
    ds_read_b128 v[164:167], v9 offset:49152
    v_add_u32 v196, 162048, v221
    s_waitcnt lgkmcnt(10)
    v_mfma_f32_32x32x16_bf16 v[48:63], v[148:151], v[168:171], v[48:63]
    ds_read_b64_tr_b16 v[132:133], v240 offset:16416
    ds_read_b64_tr_b16 v[134:135], v240 offset:17440
    v_lshlrev_b32 v221, 2, v1
    s_waitcnt lgkmcnt(12)
    v_mfma_f32_32x32x16_bf16 v[64:79], v[148:151], v[172:175], v[64:79]
    s_add_u32 s74, s73, 57344
    s_add_u32 m0, s62, 49152
    s_nop 0
    buffer_load_dwordx4 v244, s[32:35], s73 offen lds
    ds_read_b64_tr_b16 v[136:137], v240 offset:16448
    ds_read_b64_tr_b16 v[138:139], v240 offset:17472
    v_xor_b32 v199, 128, v254
    s_waitcnt lgkmcnt(12)
    v_mfma_f32_32x32x16_bf16 v[80:95], v[152:155], v[168:171], v[80:95]
    s_add_u32 m0, s62, 53248
    s_nop 0
    buffer_load_dwordx4 v245, s[36:39], s73 offen lds
    ds_read_b64_tr_b16 v[140:141], v242 offset:16384
    ds_read_b64_tr_b16 v[142:143], v242 offset:17408
    v_lshrrev_b32 v224, 5, v1
    s_waitcnt lgkmcnt(14)
    v_mfma_f32_32x32x16_bf16 v[96:111], v[152:155], v[172:175], v[96:111]
    s_add_u32 s73, s73, 114688
    s_cmp_eq_u32 s73, 1605632
    s_cselect_b32 s73, 0, s73
    s_add_u32 m0, s62, 57344
    s_nop 0
    buffer_load_dwordx4 v244, s[32:35], s74 offen lds
    v_lshlrev_b32 v225, 4, v224
    s_waitcnt lgkmcnt(12)
    v_mfma_f32_32x32x16_bf16 v[112:127], v[156:159], v[168:171], v[112:127]
    s_add_u32 m0, s62, 61440
    s_nop 0
    buffer_load_dwordx4 v245, s[36:39], s74 offen lds
    s_waitcnt lgkmcnt(7)
    v_mfma_f32_32x32x16_bf16 v[16:31], v[128:131], v[160:163], v[16:31]
    ds_read_b128 v[168:171], v8 offset:49152
    ds_read_b64_tr_b16 v[144:145], v241 offset:16384
    v_add_u32 v197, s75, v221
    s_waitcnt lgkmcnt(8)
    v_mfma_f32_32x32x16_bf16 v[32:47], v[128:131], v[164:167], v[32:47]
    ds_read_b64_tr_b16 v[146:147], v241 offset:17408
    ds_read_b128 v[172:175], v10 offset:49152
    v_mfma_f32_16x16x32_bf16 v[176:179], v[246:249], v[128:131], v[176:179]
    v_add_u32 v198, 162048, v221
    s_waitcnt lgkmcnt(8)
    v_mfma_f32_32x32x16_bf16 v[48:63], v[132:135], v[160:163], v[48:63]
    ds_read_b64_tr_b16 v[148:149], v241 offset:16416
    ds_read_b64_tr_b16 v[150:151], v241 offset:17440
    v_lshrrev_b32 v226, 3, v1
    s_waitcnt lgkmcnt(10)
    v_mfma_f32_32x32x16_bf16 v[64:79], v[132:135], v[164:167], v[64:79]
    ds_read_b64_tr_b16 v[152:153], v241 offset:16448
    ds_read_b64_tr_b16 v[154:155], v241 offset:17472
    v_mfma_f32_16x16x32_bf16 v[180:183], v[246:249], v[132:135], v[180:183]
    v_mul_u32_u24 v226, 896, v226
    s_waitcnt lgkmcnt(10)
    v_mfma_f32_32x32x16_bf16 v[80:95], v[136:139], v[160:163], v[80:95]
    ds_read_b64_tr_b16 v[156:157], v243 offset:16384
    ds_read_b64_tr_b16 v[158:159], v243 offset:17408
    s_waitcnt vmcnt(4)
    ds_add_u32 v2, v3 offset:60
    v_bfe_u32 v227, v1, 4, 1
    s_waitcnt lgkmcnt(13)
    v_mfma_f32_32x32x16_bf16 v[96:111], v[136:139], v[164:167], v[96:111]
    v_mfma_f32_16x16x32_bf16 v[184:187], v[246:249], v[136:139], v[184:187]
    v_lshlrev_b32 v228, 2, v227
    s_waitcnt lgkmcnt(11)
    v_mfma_f32_32x32x16_bf16 v[112:127], v[140:143], v[160:163], v[112:127]
    v_mfma_f32_16x16x32_bf16 v[188:191], v[246:249], v[140:143], v[188:191]
    ds_read_b32 v252, v6 offset:60
    s_waitcnt lgkmcnt(9)
    v_mfma_f32_32x32x16_bf16 v[16:31], v[144:147], v[168:171], v[16:31]
    s_waitcnt lgkmcnt(0)
    v_readfirstlane_b32 s97, v252
    s_nop 1
    s_cmp_ge_u32 s97, 4
    s_cbranch_scc1 ok_31
    s_mov_b32 s96, 0
sw_32:
    ds_read_b32 v252, v6 offset:60
    s_add_u32 s96, s96, 1
    s_waitcnt lgkmcnt(0)
    v_readfirstlane_b32 s97, v252
    s_nop 1
    s_cmp_ge_u32 s97, 4
    s_cbranch_scc1 ok_31
    s_cmp_ge_u32 s96, 160000
    s_cbranch_scc1 ok_31
    s_sleep 1
    s_branch sw_32
ok_31:
    ds_read_b128 v[160:163], v7 offset:49664
    ds_read_b64_tr_b16 v[128:129], v240 offset:32768
    v_and_b32 v229, 7, v1
    s_waitcnt lgkmcnt(10)
    v_mfma_f32_32x32x16_bf16 v[32:47], v[144:147], v[172:175], v[32:47]
    ds_read_b64_tr_b16 v[130:131], v240 offset:33792
    ds_read_b128 v[164:167], v9 offset:49664
    v_lshlrev_b32 v201, 2, v229
    s_waitcnt lgkmcnt(10)
    v_mfma_f32_32x32x16_bf16 v[48:63], v[148:151], v[168:171], v[48:63]
    ds_read_b64_tr_b16 v[132:133], v240 offset:32800
    ds_read_b64_tr_b16 v[134:135], v240 offset:33824
    v_xor_b32 v228, v228, v229
    s_waitcnt lgkmcnt(12)
    v_mfma_f32_32x32x16_bf16 v[64:79], v[148:151], v[172:175], v[64:79]
    s_add_u32 s74, s73, 57344
    s_add_u32 m0, s62, 0
    s_nop 0
    buffer_load_dwordx4 v244, s[32:35], s73 offen lds
    ds_read_b64_tr_b16 v[136:137], v240 offset:32832
    ds_read_b64_tr_b16 v[138:139], v240 offset:33856
    v_lshl_add_u32 v226, v228, 4, v226
    s_waitcnt lgkmcnt(12)
    v_mfma_f32_32x32x16_bf16 v[80:95], v[152:155], v[168:171], v[80:95]
    s_add_u32 m0, s62, 4096
    s_nop 0
    buffer_load_dwordx4 v245, s[36:39], s73 offen lds
    ds_read_b64_tr_b16 v[140:141], v242 offset:32768
    ds_read_b64_tr_b16 v[142:143], v242 offset:33792
    s_lshl_b32 s75, s7, 7
    s_waitcnt lgkmcnt(14)
    v_mfma_f32_32x32x16_bf16 v[96:111], v[152:155], v[172:175], v[96:111]
    s_add_u32 s73, s73, 114688
    s_cmp_eq_u32 s73, 1605632
    s_cselect_b32 s73, 0, s73
    s_add_u32 m0, s62, 8192
    s_nop 0
    buffer_load_dwordx4 v244, s[32:35], s74 offen lds
    v_add_u32 v192, s75, v226
    s_waitcnt lgkmcnt(12)
    v_mfma_f32_32x32x16_bf16 v[112:127], v[156:159], v[168:171], v[112:127]
    s_add_u32 m0, s62, 12288
    s_nop 0
    buffer_load_dwordx4 v245, s[36:39], s74 offen lds
    s_waitcnt lgkmcnt(7)
    v_mfma_f32_32x32x16_bf16 v[16:31], v[128:131], v[160:163], v[16:31]
    ds_read_b128 v[168:171], v8 offset:49664
    ds_read_b64_tr_b16 v[144:145], v241 offset:32768
    v_bfe_u32 v226, v1, 2, 2
    s_waitcnt lgkmcnt(8)
    v_mfma_f32_32x32x16_bf16 v[32:47], v[128:131], v[164:167], v[32:47]
    ds_read_b64_tr_b16 v[146:147], v241 offset:33792
    ds_read_b128 v[172:175], v10 offset:49664
    v_mfma_f32_16x16x32_bf16 v[176:179], v[246:249], v[128:131], v[176:179]
    v_lshl_add_u32 v228, v224, 2, v226
    s_waitcnt lgkmcnt(8)
    v_mfma_f32_32x32x16_bf16 v[48:63], v[132:135], v[160:163], v[48:63]
    ds_read_b64_tr_b16 v[148:149], v241 offset:32800
    ds_read_b64_tr_b16 v[150:151], v241 offset:33824
    v_lshlrev_b32 v228, 7, v228
    s_waitcnt lgkmcnt(10)
    v_mfma_f32_32x32x16_bf16 v[64:79], v[132:135], v[164:167], v[64:79]
    ds_read_b64_tr_b16 v[152:153], v241 offset:32832
    ds_read_b64_tr_b16 v[154:155], v241 offset:33856
    v_mfma_f32_16x16x32_bf16 v[180:183], v[246:249], v[132:135], v[180:183]
    v_lshrrev_b32 v226, 1, v226
    s_waitcnt lgkmcnt(10)
    v_mfma_f32_32x32x16_bf16 v[80:95], v[136:139], v[160:163], v[80:95]
    ds_read_b64_tr_b16 v[156:157], v243 offset:32768
    ds_read_b64_tr_b16 v[158:159], v243 offset:33792
    s_waitcnt vmcnt(4)
    ds_add_u32 v2, v3 offset:64
    s_lshr_b32 s76, s58, 1
    s_waitcnt lgkmcnt(13)
    v_mfma_f32_32x32x16_bf16 v[96:111], v[136:139], v[164:167], v[96:111]
    v_mfma_f32_16x16x32_bf16 v[184:187], v[246:249], v[136:139], v[184:187]
    v_xor_b32 v226, s76, v226
    s_waitcnt lgkmcnt(11)
    v_mfma_f32_32x32x16_bf16 v[112:127], v[140:143], v[160:163], v[112:127]
    v_mfma_f32_16x16x32_bf16 v[188:191], v[246:249], v[140:143], v[188:191]
    ds_read_b32 v252, v6 offset:64
    s_waitcnt lgkmcnt(9)
    v_mfma_f32_32x32x16_bf16 v[16:31], v[144:147], v[168:171], v[16:31]
    s_waitcnt lgkmcnt(0)
    v_readfirstlane_b32 s97, v252
    s_nop 1
    s_cmp_ge_u32 s97, 4
    s_cbranch_scc1 ok_33
    s_mov_b32 s96, 0
sw_34:
    ds_read_b32 v252, v6 offset:64
    s_add_u32 s96, s96, 1
    s_waitcnt lgkmcnt(0)
    v_readfirstlane_b32 s97, v252
    s_nop 1
    s_cmp_ge_u32 s97, 4
    s_cbranch_scc1 ok_33
    s_cmp_ge_u32 s96, 160000
    s_cbranch_scc1 ok_33
    s_sleep 1
    s_branch sw_34
ok_33:
    ds_read_b128 v[160:163], v11 offset:0
    ds_read_b64_tr_b16 v[128:129], v240 offset:49152
    v_lshl_add_u32 v228, v226, 6, v228
    s_waitcnt lgkmcnt(10)
    v_mfma_f32_32x32x16_bf16 v[32:47], v[144:147], v[172:175], v[32:47]
    ds_read_b64_tr_b16 v[130:131], v240 offset:50176
    ds_read_b128 v[164:167], v13 offset:0
    v_lshl_add_u32 v228, v227, 5, v228
    s_waitcnt lgkmcnt(10)
    v_mfma_f32_32x32x16_bf16 v[48:63], v[148:151], v[168:171], v[48:63]
    ds_read_b64_tr_b16 v[132:133], v240 offset:49184
    ds_read_b64_tr_b16 v[134:135], v240 offset:50208
    v_and_b32 v229, 3, v1
    s_waitcnt lgkmcnt(12)
    v_mfma_f32_32x32x16_bf16 v[64:79], v[148:151], v[172:175], v[64:79]
    s_add_u32 s74, s73, 57344
    s_add_u32 m0, s62, 16384
    s_nop 0
    buffer_load_dwordx4 v244, s[32:35], s73 offen lds
    ds_read_b64_tr_b16 v[136:137], v240 offset:49216
    ds_read_b64_tr_b16 v[138:139], v240 offset:50240
    v_lshl_add_u32 v228, v229, 3, v228
    s_waitcnt lgkmcnt(12)
    v_mfma_f32_32x32x16_bf16 v[80:95], v[152:155], v[168:171], v[80:95]
    s_add_u32 m0, s62, 20480
    s_nop 0
    buffer_load_dwordx4 v245, s[36:39], s73 offen lds
    ds_read_b64_tr_b16 v[140:141], v242 offset:49152
    ds_read_b64_tr_b16 v[142:143], v242 offset:50176
    v_add_u32 v193, s15, v228
    s_waitcnt lgkmcnt(14)
    v_mfma_f32_32x32x16_bf16 v[96:111], v[152:155], v[172:175], v[96:111]
    s_add_u32 s73, s73, 114688
    s_cmp_eq_u32 s73, 1605632
    s_cselect_b32 s73, 0, s73
    s_add_u32 m0, s62, 24576
    s_nop 0
    buffer_load_dwordx4 v244, s[32:35], s74 offen lds
    v_xor_b32 v194, 64, v193
    s_waitcnt lgkmcnt(12)
    v_mfma_f32_32x32x16_bf16 v[112:127], v[156:159], v[168:171], v[112:127]
    s_add_u32 m0, s62, 28672
    s_nop 0
    buffer_load_dwordx4 v245, s[36:39], s74 offen lds
    s_waitcnt lgkmcnt(7)
    v_mfma_f32_32x32x16_bf16 v[16:31], v[128:131], v[160:163], v[16:31]
    ds_read_b128 v[168:171], v12 offset:0
    ds_read_b64_tr_b16 v[144:145], v241 offset:49152
    v_subrev_u32 v203, 110592, v193
    s_waitcnt lgkmcnt(8)
    v_mfma_f32_32x32x16_bf16 v[32:47], v[128:131], v[164:167], v[32:47]
    ds_read_b64_tr_b16 v[146:147], v241 offset:50176
    ds_read_b128 v[172:175], v14 offset:0
    v_mfma_f32_16x16x32_bf16 v[176:179], v[246:249], v[128:131], v[176:179]
    v_subrev_u32 v204, 110592, v194
    s_waitcnt lgkmcnt(8)
    v_mfma_f32_32x32x16_bf16 v[48:63], v[132:135], v[160:163], v[48:63]
    ds_read_b64_tr_b16 v[148:149], v241 offset:49184
    ds_read_b64_tr_b16 v[150:151], v241 offset:50208
    v_add_u32 v250, s20, v228
    s_waitcnt lgkmcnt(10)
    v_mfma_f32_32x32x16_bf16 v[64:79], v[132:135], v[164:167], v[64:79]
    ds_read_b64_tr_b16 v[152:153], v241 offset:49216
    ds_read_b64_tr_b16 v[154:155], v241 offset:50240
    v_mfma_f32_16x16x32_bf16 v[180:183], v[246:249], v[132:135], v[180:183]
    v_xor_b32 v251, 64, v250
    s_waitcnt lgkmcnt(10)
    v_mfma_f32_32x32x16_bf16 v[80:95], v[136:139], v[160:163], v[80:95]
    ds_read_b64_tr_b16 v[156:157], v243 offset:49152
    ds_read_b64_tr_b16 v[158:159], v243 offset:50176
    s_waitcnt vmcnt(4)
    ds_add_u32 v2, v3 offset:68
    v_and_b32 v226, 31, v1
    s_waitcnt lgkmcnt(13)
    v_mfma_f32_32x32x16_bf16 v[96:111], v[136:139], v[164:167], v[96:111]
    v_mfma_f32_16x16x32_bf16 v[184:187], v[246:249], v[136:139], v[184:187]
    v_lshlrev_b32 v227, 7, v226
    s_waitcnt lgkmcnt(11)
    v_mfma_f32_32x32x16_bf16 v[112:127], v[140:143], v[160:163], v[112:127]
    v_mfma_f32_16x16x32_bf16 v[188:191], v[246:249], v[140:143], v[188:191]
    ds_read_b32 v252, v6 offset:68
    s_waitcnt lgkmcnt(9)
    v_mfma_f32_32x32x16_bf16 v[16:31], v[144:147], v[168:171], v[16:31]
    s_waitcnt lgkmcnt(0)
    v_readfirstlane_b32 s97, v252
    s_nop 1
    s_cmp_ge_u32 s97, 4
    s_cbranch_scc1 ok_35
    s_mov_b32 s96, 0
sw_36:
    ds_read_b32 v252, v6 offset:68
    s_add_u32 s96, s96, 1
    s_waitcnt lgkmcnt(0)
    v_readfirstlane_b32 s97, v252
    s_nop 1
    s_cmp_ge_u32 s97, 4
    s_cbranch_scc1 ok_35
    s_cmp_ge_u32 s96, 160000
    s_cbranch_scc1 ok_35
    s_sleep 1
    s_branch sw_36
ok_35:
    ds_read_b128 v[160:163], v11 offset:512
    ds_read_b64_tr_b16 v[128:129], v240 offset:0
    v_mul_u32_u24 v226, 896, v226
    s_waitcnt lgkmcnt(10)
    v_mfma_f32_32x32x16_bf16 v[32:47], v[144:147], v[172:175], v[32:47]
    ds_read_b64_tr_b16 v[130:131], v240 offset:1024
    ds_read_b128 v[164:167], v13 offset:512
    v_add_u32 v255, v226, v225
    s_waitcnt lgkmcnt(10)
    v_mfma_f32_32x32x16_bf16 v[48:63], v[148:151], v[168:171], v[48:63]
    ds_read_b64_tr_b16 v[132:133], v240 offset:32
    ds_read_b64_tr_b16 v[134:135], v240 offset:1056
    v_mul_u32_u24 v224, 114688, v224
    s_waitcnt lgkmcnt(12)
    v_mfma_f32_32x32x16_bf16 v[64:79], v[148:151], v[172:175], v[64:79]
    s_add_u32 s74, s73, 57344
    s_add_u32 m0, s62, 32768
    s_nop 0
    buffer_load_dwordx4 v244, s[32:35], s73 offen lds
    ds_read_b64_tr_b16 v[136:137], v240 offset:64
    ds_read_b64_tr_b16 v[138:139], v240 offset:1088
    v_add_u32 v202, v224, v227
    s_waitcnt lgkmcnt(12)
    v_mfma_f32_32x32x16_bf16 v[80:95], v[152:155], v[168:171], v[80:95]
    s_add_u32 m0, s62, 36864
    s_nop 0
    buffer_load_dwordx4 v245, s[36:39], s73 offen lds
    ds_read_b64_tr_b16 v[140:141], v242 offset:0
    ds_read_b64_tr_b16 v[142:143], v242 offset:1024
    v_min_u32 v200, 6, v1
    s_waitcnt lgkmcnt(14)
    v_mfma_f32_32x32x16_bf16 v[96:111], v[152:155], v[172:175], v[96:111]
    s_add_u32 s73, s73, 114688
    s_cmp_eq_u32 s73, 1605632
    s_cselect_b32 s73, 0, s73
    s_add_u32 m0, s62, 40960
    s_nop 0
    buffer_load_dwordx4 v244, s[32:35], s74 offen lds
    v_lshlrev_b32 v200, 14, v200
    s_waitcnt lgkmcnt(12)
    v_mfma_f32_32x32x16_bf16 v[112:127], v[156:159], v[168:171], v[112:127]
    s_add_u32 m0, s62, 45056
    s_nop 0
    buffer_load_dwordx4 v245, s[36:39], s74 offen lds
    s_waitcnt lgkmcnt(7)
    v_mfma_f32_32x32x16_bf16 v[16:31], v[128:131], v[160:163], v[16:31]
    ds_read_b128 v[168:171], v12 offset:512
    ds_read_b64_tr_b16 v[144:145], v241 offset:0
    s_waitcnt lgkmcnt(8)
    v_mfma_f32_32x32x16_bf16 v[32:47], v[128:131], v[164:167], v[32:47]
    ds_read_b64_tr_b16 v[146:147], v241 offset:1024
    ds_read_b128 v[172:175], v14 offset:512
    v_mfma_f32_16x16x32_bf16 v[176:179], v[246:249], v[128:131], v[176:179]
    s_waitcnt lgkmcnt(8)
    v_mfma_f32_32x32x16_bf16 v[48:63], v[132:135], v[160:163], v[48:63]
    ds_read_b64_tr_b16 v[148:149], v241 offset:32
    ds_read_b64_tr_b16 v[150:151], v241 offset:1056
    s_waitcnt lgkmcnt(10)
    v_mfma_f32_32x32x16_bf16 v[64:79], v[132:135], v[164:167], v[64:79]
    ds_read_b64_tr_b16 v[152:153], v241 offset:64
    ds_read_b64_tr_b16 v[154:155], v241 offset:1088
    v_mfma_f32_16x16x32_bf16 v[180:183], v[246:249], v[132:135], v[180:183]
    s_waitcnt lgkmcnt(10)
    v_mfma_f32_32x32x16_bf16 v[80:95], v[136:139], v[160:163], v[80:95]
    ds_read_b64_tr_b16 v[156:157], v243 offset:0
    ds_read_b64_tr_b16 v[158:159], v243 offset:1024
    s_waitcnt vmcnt(4)
    ds_add_u32 v2, v3 offset:72
    s_waitcnt lgkmcnt(13)
    v_mfma_f32_32x32x16_bf16 v[96:111], v[136:139], v[164:167], v[96:111]
    v_mfma_f32_16x16x32_bf16 v[184:187], v[246:249], v[136:139], v[184:187]
    s_waitcnt lgkmcnt(11)
    v_mfma_f32_32x32x16_bf16 v[112:127], v[140:143], v[160:163], v[112:127]
    v_mfma_f32_16x16x32_bf16 v[188:191], v[246:249], v[140:143], v[188:191]
    ds_read_b32 v252, v6 offset:72
    s_waitcnt lgkmcnt(9)
    v_mfma_f32_32x32x16_bf16 v[16:31], v[144:147], v[168:171], v[16:31]
    s_waitcnt lgkmcnt(0)
    v_readfirstlane_b32 s97, v252
    s_nop 1
    s_cmp_ge_u32 s97, 4
    s_cbranch_scc1 ok_37
    s_mov_b32 s96, 0
sw_38:
    ds_read_b32 v252, v6 offset:72
    s_add_u32 s96, s96, 1
    s_waitcnt lgkmcnt(0)
    v_readfirstlane_b32 s97, v252
    s_nop 1
    s_cmp_ge_u32 s97, 4
    s_cbranch_scc1 ok_37
    s_cmp_ge_u32 s96, 160000
    s_cbranch_scc1 ok_37
    s_sleep 1
    s_branch sw_38
ok_37:
    ds_read_b128 v[160:163], v7 offset:0
    ds_read_b64_tr_b16 v[128:129], v240 offset:16384
    s_waitcnt lgkmcnt(10)
    v_mfma_f32_32x32x16_bf16 v[32:47], v[144:147], v[172:175], v[32:47]
    ds_read_b64_tr_b16 v[130:131], v240 offset:17408
    ds_read_b128 v[164:167], v9 offset:0
    s_waitcnt lgkmcnt(10)
    v_mfma_f32_32x32x16_bf16 v[48:63], v[148:151], v[168:171], v[48:63]
    ds_read_b64_tr_b16 v[132:133], v240 offset:16416
    ds_read_b64_tr_b16 v[134:135], v240 offset:17440
    s_waitcnt lgkmcnt(12)
    v_mfma_f32_32x32x16_bf16 v[64:79], v[148:151], v[172:175], v[64:79]
    s_add_u32 s74, s73, 57344
    s_add_u32 m0, s62, 49152
    s_nop 0
    buffer_load_dwordx4 v244, s[32:35], s73 offen lds
    ds_read_b64_tr_b16 v[136:137], v240 offset:16448
    ds_read_b64_tr_b16 v[138:139], v240 offset:17472
    s_waitcnt lgkmcnt(12)
    v_mfma_f32_32x32x16_bf16 v[80:95], v[152:155], v[168:171], v[80:95]
    s_add_u32 m0, s62, 53248
    s_nop 0
    buffer_load_dwordx4 v245, s[36:39], s73 offen lds
    ds_read_b64_tr_b16 v[140:141], v242 offset:16384
    ds_read_b64_tr_b16 v[142:143], v242 offset:17408
    s_waitcnt lgkmcnt(14)
    v_mfma_f32_32x32x16_bf16 v[96:111], v[152:155], v[172:175], v[96:111]
    s_add_u32 s73, s73, 114688
    s_cmp_eq_u32 s73, 1605632
    s_cselect_b32 s73, 0, s73
    s_add_u32 m0, s62, 57344
    s_nop 0
    buffer_load_dwordx4 v244, s[32:35], s74 offen lds
    s_waitcnt lgkmcnt(12)
    v_mfma_f32_32x32x16_bf16 v[112:127], v[156:159], v[168:171], v[112:127]
    s_add_u32 m0, s62, 61440
    s_nop 0
    buffer_load_dwordx4 v245, s[36:39], s74 offen lds
    ds_read_b32 v208, v254 offset:0
    ds_read_b32 v210, v254 offset:512
    ds_read_b32 v212, v254 offset:1024
    ds_read_b32 v214, v199 offset:0
    ds_read_b32 v216, v199 offset:512
    ds_read_b32 v218, v199 offset:1024
    s_waitcnt lgkmcnt(13)
    v_mfma_f32_32x32x16_bf16 v[16:31], v[128:131], v[160:163], v[16:31]
    ds_read_b128 v[168:171], v8 offset:0
    ds_read_b64_tr_b16 v[144:145], v241 offset:16384
    s_waitcnt lgkmcnt(14)
    v_mfma_f32_32x32x16_bf16 v[32:47], v[128:131], v[164:167], v[32:47]
    ds_read_b64_tr_b16 v[146:147], v241 offset:17408
    ds_read_b128 v[172:175], v10 offset:0
    v_mfma_f32_16x16x32_bf16 v[176:179], v[246:249], v[128:131], v[176:179]
    s_waitcnt lgkmcnt(14)
    v_mfma_f32_32x32x16_bf16 v[48:63], v[132:135], v[160:163], v[48:63]
    ds_read_b64_tr_b16 v[148:149], v241 offset:16416
    ds_read_b64_tr_b16 v[150:151], v241 offset:17440
    s_waitcnt lgkmcnt(15)
    v_mfma_f32_32x32x16_bf16 v[64:79], v[132:135], v[164:167], v[64:79]
    ds_read_b64_tr_b16 v[152:153], v241 offset:16448
    ds_read_b64_tr_b16 v[154:155], v241 offset:17472
    v_mfma_f32_16x16x32_bf16 v[180:183], v[246:249], v[132:135], v[180:183]
    s_waitcnt lgkmcnt(15)
    v_mfma_f32_32x32x16_bf16 v[80:95], v[136:139], v[160:163], v[80:95]
    ds_read_b64_tr_b16 v[156:157], v243 offset:16384
    ds_read_b64_tr_b16 v[158:159], v243 offset:17408
    s_waitcnt vmcnt(4)
    ds_add_u32 v2, v3 offset:76
    s_waitcnt lgkmcnt(15)
    v_mfma_f32_32x32x16_bf16 v[96:111], v[136:139], v[164:167], v[96:111]
    v_mfma_f32_16x16x32_bf16 v[184:187], v[246:249], v[136:139], v[184:187]
    s_waitcnt lgkmcnt(15)
    v_mfma_f32_32x32x16_bf16 v[112:127], v[140:143], v[160:163], v[112:127]
    v_mfma_f32_16x16x32_bf16 v[188:191], v[246:249], v[140:143], v[188:191]
    ds_read_b32 v252, v6 offset:76
    s_waitcnt lgkmcnt(9)
    v_mfma_f32_32x32x16_bf16 v[16:31], v[144:147], v[168:171], v[16:31]
    s_waitcnt lgkmcnt(0)
    v_readfirstlane_b32 s97, v252
    s_nop 1
    s_cmp_ge_u32 s97, 4
    s_cbranch_scc1 ok_39
    s_mov_b32 s96, 0
sw_40:
    ds_read_b32 v252, v6 offset:76
    s_add_u32 s96, s96, 1
    s_waitcnt lgkmcnt(0)
    v_readfirstlane_b32 s97, v252
    s_nop 1
    s_cmp_ge_u32 s97, 4
    s_cbranch_scc1 ok_39
    s_cmp_ge_u32 s96, 160000
    s_cbranch_scc1 ok_39
    s_sleep 1
    s_branch sw_40
ok_39:
    ds_read_b128 v[160:163], v7 offset:512
    ds_read_b64_tr_b16 v[128:129], v240 offset:32768
    s_waitcnt lgkmcnt(10)
    v_mfma_f32_32x32x16_bf16 v[32:47], v[144:147], v[172:175], v[32:47]
    ds_read_b64_tr_b16 v[130:131], v240 offset:33792
    ds_read_b128 v[164:167], v9 offset:512
    s_waitcnt lgkmcnt(10)
    v_mfma_f32_32x32x16_bf16 v[48:63], v[148:151], v[168:171], v[48:63]
    ds_read_b64_tr_b16 v[132:133], v240 offset:32800
    ds_read_b64_tr_b16 v[134:135], v240 offset:33824
    s_waitcnt lgkmcnt(12)
    v_mfma_f32_32x32x16_bf16 v[64:79], v[148:151], v[172:175], v[64:79]
    s_add_u32 s74, s73, 57344
    s_add_u32 m0, s62, 0
    s_nop 0
    buffer_load_dwordx4 v244, s[32:35], s73 offen lds
    ds_read_b64_tr_b16 v[136:137], v240 offset:32832
    ds_read_b64_tr_b16 v[138:139], v240 offset:33856
    s_waitcnt lgkmcnt(12)
    v_mfma_f32_32x32x16_bf16 v[80:95], v[152:155], v[168:171], v[80:95]
    s_add_u32 m0, s62, 4096
    s_nop 0
    buffer_load_dwordx4 v245, s[36:39], s73 offen lds
    ds_read_b64_tr_b16 v[140:141], v242 offset:32768
    ds_read_b64_tr_b16 v[142:143], v242 offset:33792
    s_waitcnt lgkmcnt(14)
    v_mfma_f32_32x32x16_bf16 v[96:111], v[152:155], v[172:175], v[96:111]
    s_add_u32 s73, s73, 114688
    s_cmp_eq_u32 s73, 1605632
    s_cselect_b32 s73, 0, s73
    s_add_u32 m0, s62, 8192
    s_nop 0
    buffer_load_dwordx4 v244, s[32:35], s74 offen lds
    s_waitcnt lgkmcnt(12)
    v_mfma_f32_32x32x16_bf16 v[112:127], v[156:159], v[168:171], v[112:127]
    s_add_u32 m0, s62, 12288
    s_nop 0
    buffer_load_dwordx4 v245, s[36:39], s74 offen lds
    s_waitcnt lgkmcnt(7)
    v_mfma_f32_32x32x16_bf16 v[16:31], v[128:131], v[160:163], v[16:31]
    ds_read_b128 v[168:171], v8 offset:512
    ds_read_b64_tr_b16 v[144:145], v241 offset:32768
    s_waitcnt lgkmcnt(8)
    v_mfma_f32_32x32x16_bf16 v[32:47], v[128:131], v[164:167], v[32:47]
    ds_read_b64_tr_b16 v[146:147], v241 offset:33792
    ds_read_b128 v[172:175], v10 offset:512
    v_mfma_f32_16x16x32_bf16 v[176:179], v[246:249], v[128:131], v[176:179]
    s_waitcnt lgkmcnt(8)
    v_mfma_f32_32x32x16_bf16 v[48:63], v[132:135], v[160:163], v[48:63]
    ds_read_b64_tr_b16 v[148:149], v241 offset:32800
    ds_read_b64_tr_b16 v[150:151], v241 offset:33824
    s_waitcnt lgkmcnt(10)
    v_mfma_f32_32x32x16_bf16 v[64:79], v[132:135], v[164:167], v[64:79]
    ds_read_b64_tr_b16 v[152:153], v241 offset:32832
    ds_read_b64_tr_b16 v[154:155], v241 offset:33856
    v_mfma_f32_16x16x32_bf16 v[180:183], v[246:249], v[132:135], v[180:183]
    s_waitcnt lgkmcnt(10)
    v_mfma_f32_32x32x16_bf16 v[80:95], v[136:139], v[160:163], v[80:95]
    ds_read_b64_tr_b16 v[156:157], v243 offset:32768
    ds_read_b64_tr_b16 v[158:159], v243 offset:33792
    s_waitcnt vmcnt(4)
    ds_add_u32 v2, v3 offset:80
    s_waitcnt lgkmcnt(13)
    v_mfma_f32_32x32x16_bf16 v[96:111], v[136:139], v[164:167], v[96:111]
    v_mfma_f32_16x16x32_bf16 v[184:187], v[246:249], v[136:139], v[184:187]
    s_waitcnt lgkmcnt(11)
    v_mfma_f32_32x32x16_bf16 v[112:127], v[140:143], v[160:163], v[112:127]
    v_mfma_f32_16x16x32_bf16 v[188:191], v[246:249], v[140:143], v[188:191]
    ds_read_b32 v252, v6 offset:80
    s_mov_b32 s32, s4
    s_mov_b32 s33, s5
    s_mov_b32 s34, 1835008
    s_mov_b32 s35, 0x20000
    s_mov_b32 s36, s18
    s_mov_b32 s37, s19
    s_mov_b32 s38, 1835008
    s_mov_b32 s39, 0x20000
    s_waitcnt lgkmcnt(9)
    v_mfma_f32_32x32x16_bf16 v[16:31], v[144:147], v[168:171], v[16:31]
    s_waitcnt lgkmcnt(0)
    v_readfirstlane_b32 s97, v252
    s_nop 1
    s_cmp_ge_u32 s97, 4
    s_cbranch_scc1 ok_41
    s_mov_b32 s96, 0
sw_42:
    ds_read_b32 v252, v6 offset:80
    s_add_u32 s96, s96, 1
    s_waitcnt lgkmcnt(0)
    v_readfirstlane_b32 s97, v252
    s_nop 1
    s_cmp_ge_u32 s97, 4
    s_cbranch_scc1 ok_41
    s_cmp_ge_u32 s96, 160000
    s_cbranch_scc1 ok_41
    s_sleep 1
    s_branch sw_42
ok_41:
    ds_read_b128 v[160:163], v7 offset:16384
    ds_read_b64_tr_b16 v[128:129], v240 offset:49152
    s_waitcnt lgkmcnt(10)
    v_mfma_f32_32x32x16_bf16 v[32:47], v[144:147], v[172:175], v[32:47]
    ds_read_b64_tr_b16 v[130:131], v240 offset:50176
    ds_read_b128 v[164:167], v9 offset:16384
    s_waitcnt lgkmcnt(10)
    v_mfma_f32_32x32x16_bf16 v[48:63], v[148:151], v[168:171], v[48:63]
    ds_read_b64_tr_b16 v[132:133], v240 offset:49184
    ds_read_b64_tr_b16 v[134:135], v240 offset:50208
    s_waitcnt lgkmcnt(12)
    v_mfma_f32_32x32x16_bf16 v[64:79], v[148:151], v[172:175], v[64:79]
    ds_read_b64_tr_b16 v[136:137], v240 offset:49216
    ds_read_b64_tr_b16 v[138:139], v240 offset:50240
    s_waitcnt lgkmcnt(12)
    v_mfma_f32_32x32x16_bf16 v[80:95], v[152:155], v[168:171], v[80:95]
    ds_read_b64_tr_b16 v[140:141], v242 offset:49152
    ds_read_b64_tr_b16 v[142:143], v242 offset:50176
    s_waitcnt lgkmcnt(14)
    v_mfma_f32_32x32x16_bf16 v[96:111], v[152:155], v[172:175], v[96:111]
    s_waitcnt lgkmcnt(12)
    v_mfma_f32_32x32x16_bf16 v[112:127], v[156:159], v[168:171], v[112:127]
    s_waitcnt lgkmcnt(7)
    v_mfma_f32_32x32x16_bf16 v[16:31], v[128:131], v[160:163], v[16:31]
    ds_read_b128 v[168:171], v8 offset:16384
    ds_read_b64_tr_b16 v[144:145], v241 offset:49152
    s_waitcnt lgkmcnt(8)
    v_mfma_f32_32x32x16_bf16 v[32:47], v[128:131], v[164:167], v[32:47]
    ds_read_b64_tr_b16 v[146:147], v241 offset:50176
    ds_read_b128 v[172:175], v10 offset:16384
    v_mfma_f32_16x16x32_bf16 v[176:179], v[246:249], v[128:131], v[176:179]
    s_waitcnt lgkmcnt(8)
    v_mfma_f32_32x32x16_bf16 v[48:63], v[132:135], v[160:163], v[48:63]
    ds_read_b64_tr_b16 v[148:149], v241 offset:49184
    ds_read_b64_tr_b16 v[150:151], v241 offset:50208
    s_waitcnt lgkmcnt(10)
    v_mfma_f32_32x32x16_bf16 v[64:79], v[132:135], v[164:167], v[64:79]
    ds_read_b64_tr_b16 v[152:153], v241 offset:49216
    ds_read_b64_tr_b16 v[154:155], v241 offset:50240
    v_mfma_f32_16x16x32_bf16 v[180:183], v[246:249], v[132:135], v[180:183]
    s_waitcnt lgkmcnt(10)
    v_mfma_f32_32x32x16_bf16 v[80:95], v[136:139], v[160:163], v[80:95]
    ds_read_b64_tr_b16 v[156:157], v243 offset:49152
    ds_read_b64_tr_b16 v[158:159], v243 offset:50176
    s_waitcnt vmcnt(0)
    ds_add_u32 v2, v3 offset:84
    s_waitcnt lgkmcnt(13)
    v_mfma_f32_32x32x16_bf16 v[96:111], v[136:139], v[164:167], v[96:111]
    v_mfma_f32_16x16x32_bf16 v[184:187], v[246:249], v[136:139], v[184:187]
    s_waitcnt lgkmcnt(11)
    v_mfma_f32_32x32x16_bf16 v[112:127], v[140:143], v[160:163], v[112:127]
    v_mfma_f32_16x16x32_bf16 v[188:191], v[246:249], v[140:143], v[188:191]
    ds_read_b32 v252, v6 offset:84
    s_lshl_b32 s75, s54, 2
    s_add_u32 s75, s75, s58
    s_mul_i32 s76, s75, 12544
    s_mul_i32 s77, s75, 3200
    v_lshlrev_b32 v222, 7, v1
    buffer_load_dword v253, v222, s[24:27], s76 offen
    v_min_u32 v244, 4224, v222
    v_add_u32 v244, 8192, v244
    v_min_u32 v245, 3072, v222
    buffer_load_dword v253, v244, s[24:27], s76 offen
    buffer_load_dword v253, v245, s[28:31], s77 offen
    s_waitcnt lgkmcnt(9)
    v_mfma_f32_32x32x16_bf16 v[16:31], v[144:147], v[168:171], v[16:31]
    s_waitcnt lgkmcnt(0)
    v_readfirstlane_b32 s97, v252
    s_nop 1
    s_cmp_ge_u32 s97, 4
    s_cbranch_scc1 ok_43
    s_mov_b32 s96, 0
sw_44:
    ds_read_b32 v252, v6 offset:84
    s_add_u32 s96, s96, 1
    s_waitcnt lgkmcnt(0)
    v_readfirstlane_b32 s97, v252
    s_nop 1
    s_cmp_ge_u32 s97, 4
    s_cbranch_scc1 ok_43
    s_cmp_ge_u32 s96, 160000
    s_cbranch_scc1 ok_43
    s_sleep 1
    s_branch sw_44
ok_43:
    ds_read_b128 v[160:163], v7 offset:16896
    ds_read_b64_tr_b16 v[128:129], v240 offset:0
    s_waitcnt lgkmcnt(10)
    v_mfma_f32_32x32x16_bf16 v[32:47], v[144:147], v[172:175], v[32:47]
    ds_read_b64_tr_b16 v[130:131], v240 offset:1024
    ds_read_b128 v[164:167], v9 offset:16896
    s_waitcnt lgkmcnt(10)
    v_mfma_f32_32x32x16_bf16 v[48:63], v[148:151], v[168:171], v[48:63]
    ds_read_b64_tr_b16 v[132:133], v240 offset:32
    ds_read_b64_tr_b16 v[134:135], v240 offset:1056
    s_waitcnt lgkmcnt(12)
    v_mfma_f32_32x32x16_bf16 v[64:79], v[148:151], v[172:175], v[64:79]
    ds_read_b64_tr_b16 v[136:137], v240 offset:64
    ds_read_b64_tr_b16 v[138:139], v240 offset:1088
    s_waitcnt lgkmcnt(12)
    v_mfma_f32_32x32x16_bf16 v[80:95], v[152:155], v[168:171], v[80:95]
    ds_read_b64_tr_b16 v[140:141], v242 offset:0
    ds_read_b64_tr_b16 v[142:143], v242 offset:1024
    s_waitcnt lgkmcnt(14)
    v_mfma_f32_32x32x16_bf16 v[96:111], v[152:155], v[172:175], v[96:111]
    s_waitcnt lgkmcnt(12)
    v_mfma_f32_32x32x16_bf16 v[112:127], v[156:159], v[168:171], v[112:127]
    s_waitcnt lgkmcnt(7)
    v_mfma_f32_32x32x16_bf16 v[16:31], v[128:131], v[160:163], v[16:31]
    ds_read_b128 v[168:171], v8 offset:16896
    ds_read_b64_tr_b16 v[144:145], v241 offset:0
    s_waitcnt lgkmcnt(8)
    v_mfma_f32_32x32x16_bf16 v[32:47], v[128:131], v[164:167], v[32:47]
    ds_read_b64_tr_b16 v[146:147], v241 offset:1024
    ds_read_b128 v[172:175], v10 offset:16896
    v_mfma_f32_16x16x32_bf16 v[176:179], v[246:249], v[128:131], v[176:179]
    s_waitcnt lgkmcnt(8)
    v_mfma_f32_32x32x16_bf16 v[48:63], v[132:135], v[160:163], v[48:63]
    ds_read_b64_tr_b16 v[148:149], v241 offset:32
    ds_read_b64_tr_b16 v[150:151], v241 offset:1056
    s_waitcnt lgkmcnt(10)
    v_mfma_f32_32x32x16_bf16 v[64:79], v[132:135], v[164:167], v[64:79]
    ds_read_b64_tr_b16 v[152:153], v241 offset:64
    ds_read_b64_tr_b16 v[154:155], v241 offset:1088
    v_mfma_f32_16x16x32_bf16 v[180:183], v[246:249], v[132:135], v[180:183]
    s_waitcnt lgkmcnt(10)
    v_mfma_f32_32x32x16_bf16 v[80:95], v[136:139], v[160:163], v[80:95]
    ds_read_b64_tr_b16 v[156:157], v243 offset:0
    ds_read_b64_tr_b16 v[158:159], v243 offset:1024
    s_waitcnt lgkmcnt(12)
    v_mfma_f32_32x32x16_bf16 v[96:111], v[136:139], v[164:167], v[96:111]
    v_mfma_f32_16x16x32_bf16 v[184:187], v[246:249], v[136:139], v[184:187]
    s_waitcnt lgkmcnt(10)
    v_mfma_f32_32x32x16_bf16 v[112:127], v[140:143], v[160:163], v[112:127]
    v_mfma_f32_16x16x32_bf16 v[188:191], v[246:249], v[140:143], v[188:191]
    s_mov_b32 exec_hi, 0
    ds_write_b32 v195, v176 offset:0
    ds_write_b32 v195, v180 offset:256
    s_nop 1
    ds_write_b32 v195, v184 offset:512
    s_nop 1
    ds_write_b32 v196, v188 offset:0
    s_mov_b32 exec_hi, -1
    s_waitcnt lgkmcnt(11)
    v_mfma_f32_32x32x16_bf16 v[16:31], v[144:147], v[168:171], v[16:31]
    s_waitcnt lgkmcnt(10)
    v_mfma_f32_32x32x16_bf16 v[32:47], v[144:147], v[172:175], v[32:47]
    s_waitcnt lgkmcnt(8)
    v_mfma_f32_32x32x16_bf16 v[48:63], v[148:151], v[168:171], v[48:63]
    s_waitcnt lgkmcnt(8)
    v_mfma_f32_32x32x16_bf16 v[64:79], v[148:151], v[172:175], v[64:79]
    s_waitcnt lgkmcnt(6)
    v_mfma_f32_32x32x16_bf16 v[80:95], v[152:155], v[168:171], v[80:95]
    s_waitcnt lgkmcnt(6)
    v_mfma_f32_32x32x16_bf16 v[96:111], v[152:155], v[172:175], v[96:111]
    s_waitcnt lgkmcnt(4)
    v_mfma_f32_32x32x16_bf16 v[112:127], v[156:159], v[168:171], v[112:127]
    ds_add_u32 v2, v3 offset:12
    s_mov_b32 s96, 0
sw_46:
    ds_read_b32 v220, v6 offset:12
    s_add_u32 s96, s96, 1
    s_waitcnt lgkmcnt(0)
    v_readfirstlane_b32 s97, v220
    s_nop 1
    s_cmp_ge_u32 s97, 8
    s_cbranch_scc1 ok_45
    s_cmp_ge_u32 s96, 160000
    s_cbranch_scc1 ok_45
    s_sleep 1
    s_branch sw_46
ok_45:
    ds_read_b32 v128, v197 offset:0
    ds_read_b32 v129, v197 offset:256
    ds_read_b32 v130, v197 offset:512
    ds_read_b32 v131, v198 offset:0
    s_waitcnt lgkmcnt(3)
    v_mfma_f32_32x32x2_f32 v[16:31], v128, v208, v[16:31]
    s_waitcnt lgkmcnt(3)
    v_mfma_f32_32x32x2_f32 v[32:47], v128, v214, v[32:47]
    s_nop 15
    s_nop 1
    v_mul_f32 v16, v16, v210
    v_mul_f32 v17, v17, v210
    v_mul_f32 v18, v18, v210
    v_mul_f32 v19, v19, v210
    v_mul_f32 v20, v20, v210
    v_mul_f32 v21, v21, v210
    v_mul_f32 v22, v22, v210
    v_mul_f32 v23, v23, v210
    s_waitcnt lgkmcnt(2)
    v_mfma_f32_32x32x2_f32 v[48:63], v129, v208, v[48:63]
    v_exp_f32 v16, v16
    v_exp_f32 v17, v17
    v_exp_f32 v18, v18
    v_exp_f32 v19, v19
    v_exp_f32 v20, v20
    v_exp_f32 v21, v21
    v_exp_f32 v22, v22
    v_exp_f32 v23, v23
    v_fma_f32 v16, v16, v212, v212
    v_fma_f32 v17, v17, v212, v212
    v_fma_f32 v18, v18, v212, v212
    v_fma_f32 v19, v19, v212, v212
    v_fma_f32 v20, v20, v212, v212
    v_fma_f32 v21, v21, v212, v212
    v_fma_f32 v22, v22, v212, v212
    v_fma_f32 v23, v23, v212, v212
    v_rcp_f32 v16, v16
    v_rcp_f32 v17, v17
    v_rcp_f32 v18, v18
    v_rcp_f32 v19, v19
    v_rcp_f32 v20, v20
    v_rcp_f32 v21, v21
    v_rcp_f32 v22, v22
    v_rcp_f32 v23, v23
    v_mul_f32 v16, v16, v24
    v_mul_f32 v17, v17, v25
    v_mul_f32 v18, v18, v26
    v_mul_f32 v19, v19, v27
    v_mul_f32 v20, v20, v28
    v_mul_f32 v21, v21, v29
    v_mul_f32 v22, v22, v30
    v_mul_f32 v23, v23, v31
    v_cvt_pk_bf16_f32 v24, v16, v17
    v_cvt_pk_bf16_f32 v25, v18, v19
    v_cvt_pk_bf16_f32 v26, v20, v21
    v_cvt_pk_bf16_f32 v27, v22, v23
    buffer_store_dwordx4 v[24:27], v15, s[40:43], s70 offen offset:0 sc1
    v_mul_f32 v32, v32, v216
    v_mul_f32 v33, v33, v216
    v_mul_f32 v34, v34, v216
    v_mul_f32 v35, v35, v216
    v_mul_f32 v36, v36, v216
    v_mul_f32 v37, v37, v216
    v_mul_f32 v38, v38, v216
    v_mul_f32 v39, v39, v216
    s_waitcnt lgkmcnt(2)
    v_mfma_f32_32x32x2_f32 v[64:79], v129, v214, v[64:79]
    v_exp_f32 v32, v32
    v_exp_f32 v33, v33
    v_exp_f32 v34, v34
    v_exp_f32 v35, v35
    v_exp_f32 v36, v36
    v_exp_f32 v37, v37
    v_exp_f32 v38, v38
    v_exp_f32 v39, v39
    v_fma_f32 v32, v32, v218, v218
    v_fma_f32 v33, v33, v218, v218
    v_fma_f32 v34, v34, v218, v218
    v_fma_f32 v35, v35, v218, v218
    v_fma_f32 v36, v36, v218, v218
    v_fma_f32 v37, v37, v218, v218
    v_fma_f32 v38, v38, v218, v218
    v_fma_f32 v39, v39, v218, v218
    v_rcp_f32 v32, v32
    v_rcp_f32 v33, v33
    v_rcp_f32 v34, v34
    v_rcp_f32 v35, v35
    v_rcp_f32 v36, v36
    v_rcp_f32 v37, v37
    v_rcp_f32 v38, v38
    v_rcp_f32 v39, v39
    v_mul_f32 v32, v32, v40
    v_mul_f32 v33, v33, v41
    v_mul_f32 v34, v34, v42
    v_mul_f32 v35, v35, v43
    v_mul_f32 v36, v36, v44
    v_mul_f32 v37, v37, v45
    v_mul_f32 v38, v38, v46
    v_mul_f32 v39, v39, v47
    v_cvt_pk_bf16_f32 v40, v32, v33
    v_cvt_pk_bf16_f32 v41, v34, v35
    v_cvt_pk_bf16_f32 v42, v36, v37
    v_cvt_pk_bf16_f32 v43, v38, v39
    buffer_store_dwordx4 v[40:43], v15, s[40:43], s71 offen offset:0 sc1
    v_mul_f32 v48, v48, v210
    v_mul_f32 v49, v49, v210
    v_mul_f32 v50, v50, v210
    v_mul_f32 v51, v51, v210
    v_mul_f32 v52, v52, v210
    v_mul_f32 v53, v53, v210
    v_mul_f32 v54, v54, v210
    v_mul_f32 v55, v55, v210
    s_waitcnt lgkmcnt(1)
    v_mfma_f32_32x32x2_f32 v[80:95], v130, v208, v[80:95]
    v_exp_f32 v48, v48
    v_exp_f32 v49, v49
    v_exp_f32 v50, v50
    v_exp_f32 v51, v51
    v_exp_f32 v52, v52
    v_exp_f32 v53, v53
    v_exp_f32 v54, v54
    v_exp_f32 v55, v55
    v_fma_f32 v48, v48, v212, v212
    v_fma_f32 v49, v49, v212, v212
    v_fma_f32 v50, v50, v212, v212
    v_fma_f32 v51, v51, v212, v212
    v_fma_f32 v52, v52, v212, v212
    v_fma_f32 v53, v53, v212, v212
    v_fma_f32 v54, v54, v212, v212
    v_fma_f32 v55, v55, v212, v212
    v_rcp_f32 v48, v48
    v_rcp_f32 v49, v49
    v_rcp_f32 v50, v50
    v_rcp_f32 v51, v51
    v_rcp_f32 v52, v52
    v_rcp_f32 v53, v53
    v_rcp_f32 v54, v54
    v_rcp_f32 v55, v55
    v_mul_f32 v48, v48, v56
    v_mul_f32 v49, v49, v57
    v_mul_f32 v50, v50, v58
    v_mul_f32 v51, v51, v59
    v_mul_f32 v52, v52, v60
    v_mul_f32 v53, v53, v61
    v_mul_f32 v54, v54, v62
    v_mul_f32 v55, v55, v63
    v_cvt_pk_bf16_f32 v56, v48, v49
    v_cvt_pk_bf16_f32 v57, v50, v51
    v_cvt_pk_bf16_f32 v58, v52, v53
    v_cvt_pk_bf16_f32 v59, v54, v55
    buffer_store_dwordx4 v[56:59], v15, s[40:43], s70 offen offset:1024 sc1
    v_mul_f32 v64, v64, v216
    v_mul_f32 v65, v65, v216
    v_mul_f32 v66, v66, v216
    v_mul_f32 v67, v67, v216
    v_mul_f32 v68, v68, v216
    v_mul_f32 v69, v69, v216
    v_mul_f32 v70, v70, v216
    v_mul_f32 v71, v71, v216
    s_waitcnt lgkmcnt(1)
    v_mfma_f32_32x32x2_f32 v[96:111], v130, v214, v[96:111]
    v_exp_f32 v64, v64
    v_exp_f32 v65, v65
    v_exp_f32 v66, v66
    v_exp_f32 v67, v67
    v_exp_f32 v68, v68
    v_exp_f32 v69, v69
    v_exp_f32 v70, v70
    v_exp_f32 v71, v71
    v_fma_f32 v64, v64, v218, v218
    v_fma_f32 v65, v65, v218, v218
    v_fma_f32 v66, v66, v218, v218
    v_fma_f32 v67, v67, v218, v218
    v_fma_f32 v68, v68, v218, v218
    v_fma_f32 v69, v69, v218, v218
    v_fma_f32 v70, v70, v218, v218
    v_fma_f32 v71, v71, v218, v218
    v_rcp_f32 v64, v64
    v_rcp_f32 v65, v65
    v_rcp_f32 v66, v66
    v_rcp_f32 v67, v67
    v_rcp_f32 v68, v68
    v_rcp_f32 v69, v69
    v_rcp_f32 v70, v70
    v_rcp_f32 v71, v71
    v_mul_f32 v64, v64, v72
    v_mul_f32 v65, v65, v73
    v_mul_f32 v66, v66, v74
    v_mul_f32 v67, v67, v75
    v_mul_f32 v68, v68, v76
    v_mul_f32 v69, v69, v77
    v_mul_f32 v70, v70, v78
    v_mul_f32 v71, v71, v79
    v_cvt_pk_bf16_f32 v72, v64, v65
    v_cvt_pk_bf16_f32 v73, v66, v67
    v_cvt_pk_bf16_f32 v74, v68, v69
    v_cvt_pk_bf16_f32 v75, v70, v71
    buffer_store_dwordx4 v[72:75], v15, s[40:43], s71 offen offset:1024 sc1
    v_mul_f32 v80, v80, v210
    v_mul_f32 v81, v81, v210
    v_mul_f32 v82, v82, v210
    v_mul_f32 v83, v83, v210
    v_mul_f32 v84, v84, v210
    v_mul_f32 v85, v85, v210
    v_mul_f32 v86, v86, v210
    v_mul_f32 v87, v87, v210
    s_waitcnt lgkmcnt(0)
    v_mfma_f32_32x32x2_f32 v[112:127], v131, v208, v[112:127]
    v_exp_f32 v80, v80
    v_exp_f32 v81, v81
    v_exp_f32 v82, v82
    v_exp_f32 v83, v83
    v_exp_f32 v84, v84
    v_exp_f32 v85, v85
    v_exp_f32 v86, v86
    v_exp_f32 v87, v87
    v_fma_f32 v80, v80, v212, v212
    v_fma_f32 v81, v81, v212, v212
    v_fma_f32 v82, v82, v212, v212
    v_fma_f32 v83, v83, v212, v212
    v_fma_f32 v84, v84, v212, v212
    v_fma_f32 v85, v85, v212, v212
    v_fma_f32 v86, v86, v212, v212
    v_fma_f32 v87, v87, v212, v212
    v_rcp_f32 v80, v80
    v_rcp_f32 v81, v81
    v_rcp_f32 v82, v82
    v_rcp_f32 v83, v83
    v_rcp_f32 v84, v84
    v_rcp_f32 v85, v85
    v_rcp_f32 v86, v86
    v_rcp_f32 v87, v87
    v_mul_f32 v80, v80, v88
    v_mul_f32 v81, v81, v89
    v_mul_f32 v82, v82, v90
    v_mul_f32 v83, v83, v91
    v_mul_f32 v84, v84, v92
    v_mul_f32 v85, v85, v93
    v_mul_f32 v86, v86, v94
    v_mul_f32 v87, v87, v95
    v_cvt_pk_bf16_f32 v88, v80, v81
    v_cvt_pk_bf16_f32 v89, v82, v83
    v_cvt_pk_bf16_f32 v90, v84, v85
    v_cvt_pk_bf16_f32 v91, v86, v87
    buffer_store_dwordx4 v[88:91], v15, s[40:43], s70 offen offset:2048 sc1
    v_mul_f32 v96, v96, v216
    v_mul_f32 v97, v97, v216
    v_mul_f32 v98, v98, v216
    v_mul_f32 v99, v99, v216
    v_mul_f32 v100, v100, v216
    v_mul_f32 v101, v101, v216
    v_mul_f32 v102, v102, v216
    v_mul_f32 v103, v103, v216
    v_exp_f32 v96, v96
    v_exp_f32 v97, v97
    v_exp_f32 v98, v98
    v_exp_f32 v99, v99
    v_exp_f32 v100, v100
    v_exp_f32 v101, v101
    v_exp_f32 v102, v102
    v_exp_f32 v103, v103
    v_fma_f32 v96, v96, v218, v218
    v_fma_f32 v97, v97, v218, v218
    v_fma_f32 v98, v98, v218, v218
    v_fma_f32 v99, v99, v218, v218
    v_fma_f32 v100, v100, v218, v218
    v_fma_f32 v101, v101, v218, v218
    v_fma_f32 v102, v102, v218, v218
    v_fma_f32 v103, v103, v218, v218
    v_rcp_f32 v96, v96
    v_rcp_f32 v97, v97
    v_rcp_f32 v98, v98
    v_rcp_f32 v99, v99
    v_rcp_f32 v100, v100
    v_rcp_f32 v101, v101
    v_rcp_f32 v102, v102
    v_rcp_f32 v103, v103
    v_mul_f32 v96, v96, v104
    v_mul_f32 v97, v97, v105
    v_mul_f32 v98, v98, v106
    v_mul_f32 v99, v99, v107
    v_mul_f32 v100, v100, v108
    v_mul_f32 v101, v101, v109
    v_mul_f32 v102, v102, v110
    v_mul_f32 v103, v103, v111
    v_cvt_pk_bf16_f32 v104, v96, v97
    v_cvt_pk_bf16_f32 v105, v98, v99
    v_cvt_pk_bf16_f32 v106, v100, v101
    v_cvt_pk_bf16_f32 v107, v102, v103
    buffer_store_dwordx4 v[104:107], v15, s[40:43], s71 offen offset:2048 sc1
    v_mul_f32 v112, v112, v210
    v_mul_f32 v113, v113, v210
    v_mul_f32 v114, v114, v210
    v_mul_f32 v115, v115, v210
    v_mul_f32 v116, v116, v210
    v_mul_f32 v117, v117, v210
    v_mul_f32 v118, v118, v210
    v_mul_f32 v119, v119, v210
    v_exp_f32 v112, v112
    v_exp_f32 v113, v113
    v_exp_f32 v114, v114
    v_exp_f32 v115, v115
    v_exp_f32 v116, v116
    v_exp_f32 v117, v117
    v_exp_f32 v118, v118
    v_exp_f32 v119, v119
    v_fma_f32 v112, v112, v212, v212
    v_fma_f32 v113, v113, v212, v212
    v_fma_f32 v114, v114, v212, v212
    v_fma_f32 v115, v115, v212, v212
    v_fma_f32 v116, v116, v212, v212
    v_fma_f32 v117, v117, v212, v212
    v_fma_f32 v118, v118, v212, v212
    v_fma_f32 v119, v119, v212, v212
    v_rcp_f32 v112, v112
    v_rcp_f32 v113, v113
    v_rcp_f32 v114, v114
    v_rcp_f32 v115, v115
    v_rcp_f32 v116, v116
    v_rcp_f32 v117, v117
    v_rcp_f32 v118, v118
    v_rcp_f32 v119, v119
    v_mul_f32 v112, v112, v120
    v_mul_f32 v113, v113, v121
    v_mul_f32 v114, v114, v122
    v_mul_f32 v115, v115, v123
    v_mul_f32 v116, v116, v124
    v_mul_f32 v117, v117, v125
    v_mul_f32 v118, v118, v126
    v_mul_f32 v119, v119, v127
    v_cvt_pk_bf16_f32 v120, v112, v113
    v_cvt_pk_bf16_f32 v121, v114, v115
    v_cvt_pk_bf16_f32 v122, v116, v117
    v_cvt_pk_bf16_f32 v123, v118, v119
    buffer_store_dwordx4 v[120:123], v15, s[40:43], s72 offen offset:0 sc1
    s_waitcnt vmcnt(0)
    buffer_store_dword v3, v200, s[40:43], s21 offen sc1
    s_setprio 2
    s_cmp_ge_u32 s54, 28
    s_cbranch_scc1 fz_gnd
    s_add_u32 m0, s15, 0
    s_nop 0
    buffer_load_dwordx4 v192, s[24:27], s11 offen lds
    s_add_u32 s11, s11, 7168
    s_add_u32 m0, s15, 1024
    s_nop 0
    buffer_load_dwordx4 v192, s[24:27], s11 offen lds
    s_add_u32 s11, s11, 7168
    s_add_u32 m0, s15, 2048
    s_nop 0
    buffer_load_dwordx4 v192, s[24:27], s11 offen lds
    s_add_u32 s11, s11, 7168
    s_add_u32 m0, s15, 3072
    s_nop 0
    buffer_load_dwordx4 v192, s[24:27], s11 offen lds
    s_add_u32 s11, s11, 7168
    s_add_u32 m0, s15, 4096
    s_nop 0
    buffer_load_dwordx4 v192, s[24:27], s11 offen lds
    s_add_u32 s11, s11, 7168
    s_add_u32 m0, s15, 5120
    s_nop 0
    buffer_load_dwordx4 v192, s[24:27], s11 offen lds
    s_add_u32 s11, s11, 7168
    s_add_u32 m0, s15, 6144
    s_nop 0
    buffer_load_dwordx4 v192, s[24:27], s11 offen lds
    s_add_u32 s11, s11, 7168
    s_add_u32 m0, s15, 7168
    s_nop 0
    buffer_load_dwordx4 v192, s[24:27], s11 offen lds
    s_add_u32 s11, s11, 7168
    s_add_u32 m0, s15, 8192
    s_nop 0
    buffer_load_dwordx4 v192, s[24:27], s11 offen lds
    s_add_u32 s11, s11, 7168
    s_add_u32 m0, s15, 9216
    s_nop 0
    buffer_load_dwordx4 v192, s[24:27], s11 offen lds
    s_add_u32 s11, s11, 7168
    s_add_u32 m0, s15, 10240
    s_nop 0
    buffer_load_dwordx4 v192, s[24:27], s11 offen lds
    s_add_u32 s11, s11, 7168
    s_add_u32 m0, s15, 11264
    s_nop 0
    buffer_load_dwordx4 v192, s[24:27], s11 offen lds
    s_add_u32 s11, s11, 7168
    buffer_load_dwordx4 v[224:227], v255, s[32:35], s14 offen offset:0
    buffer_load_dwordx4 v[228:231], v255, s[32:35], s14 offen offset:32
    s_mul_i32 s73, s58, 100352
    s_sleep 8
    s_mov_b32 s96, 0
pl_47:
    buffer_load_dword v246, v201, s[40:43], s22 offen sc1
    s_add_u32 s96, s96, 1
    s_waitcnt vmcnt(0)
    v_cmp_ne_u32 vcc, 1, v246
    s_cmp_ge_u32 s96, 20000
    s_cbranch_scc1 pl_47_ok
    s_nop 2
    s_cbranch_vccz pl_47_ok
    s_sleep 4
    s_branch pl_47
pl_47_ok:
    ds_read_b64_tr_b16 v[176:177], v193 offset:0
    ds_read_b64_tr_b16 v[178:179], v193 offset:1024
    ds_read_b64_tr_b16 v[180:181], v194 offset:0
    ds_read_b64_tr_b16 v[182:183], v194 offset:1024
    buffer_load_dwordx4 v[80:83], v15, s[40:43], s12 offen offset:0
    buffer_load_dwordx4 v[84:87], v15, s[40:43], s13 offen offset:0
    buffer_load_dwordx4 v[88:91], v15, s[40:43], s12 offen offset:1024
    buffer_load_dwordx4 v[92:95], v15, s[40:43], s13 offen offset:1024
    buffer_load_dwordx4 v[96:99], v15, s[40:43], s12 offen offset:2048
    buffer_load_dwordx4 v[100:103], v15, s[40:43], s13 offen offset:2048
    buffer_load_dwordx4 v[104:107], v15, s[40:43], s12 offen offset:3072
    buffer_load_dwordx4 v[108:111], v15, s[40:43], s13 offen offset:3072
    s_add_u32 s12, s12, 4096
    s_add_u32 s13, s13, 4096
    buffer_load_dwordx4 v[112:115], v15, s[40:43], s12 offen offset:0
    buffer_load_dwordx4 v[116:119], v15, s[40:43], s13 offen offset:0
    buffer_load_dwordx4 v[120:123], v15, s[40:43], s12 offen offset:1024
    buffer_load_dwordx4 v[124:127], v15, s[40:43], s13 offen offset:1024
    buffer_load_dwordx4 v[128:131], v15, s[40:43], s12 offen offset:2048
    buffer_load_dwordx4 v[132:135], v15, s[40:43], s13 offen offset:2048
    buffer_load_dwordx4 v[136:139], v15, s[40:43], s12 offen offset:3072
    buffer_load_dwordx4 v[140:143], v15, s[40:43], s13 offen offset:3072
    s_add_u32 s12, s12, 4096
    s_add_u32 s13, s13, 4096
    buffer_load_dwordx4 v[144:147], v15, s[40:43], s12 offen offset:0
    buffer_load_dwordx4 v[148:151], v15, s[40:43], s13 offen offset:0
    buffer_load_dwordx4 v[152:155], v15, s[40:43], s12 offen offset:1024
    buffer_load_dwordx4 v[156:159], v15, s[40:43], s13 offen offset:1024
    buffer_load_dwordx4 v[160:163], v15, s[40:43], s12 offen offset:2048
    buffer_load_dwordx4 v[164:167], v15, s[40:43], s13 offen offset:2048
    buffer_load_dwordx4 v[168:171], v15, s[40:43], s12 offen offset:3072
    buffer_load_dwordx4 v[172:175], v15, s[40:43], s13 offen offset:3072
    s_add_u32 s12, s12, 4096
    s_add_u32 s13, s13, 4096
    ds_read_b64_tr_b16 v[184:185], v193 offset:2048
    ds_read_b64_tr_b16 v[186:187], v193 offset:3072
    ds_read_b64_tr_b16 v[188:189], v194 offset:2048
    ds_read_b64_tr_b16 v[190:191], v194 offset:3072
    s_waitcnt lgkmcnt(6)
    s_waitcnt vmcnt(23)
    v_mfma_f32_32x32x16_bf16 v[16:31], v[176:179], v[80:83], 0
    s_waitcnt vmcnt(22)
    v_mfma_f32_32x32x16_bf16 v[32:47], v[176:179], v[84:87], 0
    s_waitcnt lgkmcnt(4)
    v_mfma_f32_32x32x16_bf16 v[48:63], v[180:183], v[80:83], 0
    s_add_u32 m0, s15, 0
    s_nop 0
    buffer_load_dwordx4 v192, s[24:27], s11 offen lds
    s_add_u32 s11, s11, 7168
    s_add_u32 m0, s15, 1024
    s_nop 0
    buffer_load_dwordx4 v192, s[24:27], s11 offen lds
    s_add_u32 s11, s11, 7168
    v_mfma_f32_32x32x16_bf16 v[64:79], v[180:183], v[84:87], 0
    buffer_load_dwordx4 v[80:83], v15, s[40:43], s12 offen offset:0
    buffer_load_dwordx4 v[84:87], v15, s[40:43], s13 offen offset:0
    ds_read_b64_tr_b16 v[176:177], v193 offset:4096
    ds_read_b64_tr_b16 v[178:179], v193 offset:5120
    ds_read_b64_tr_b16 v[180:181], v194 offset:4096
    ds_read_b64_tr_b16 v[182:183], v194 offset:5120
    s_waitcnt lgkmcnt(6)
    s_waitcnt vmcnt(25)
    v_mfma_f32_32x32x16_bf16 v[16:31], v[184:187], v[88:91], v[16:31]
    s_waitcnt vmcnt(24)
    v_mfma_f32_32x32x16_bf16 v[32:47], v[184:187], v[92:95], v[32:47]
    s_waitcnt lgkmcnt(4)
    v_mfma_f32_32x32x16_bf16 v[48:63], v[188:191], v[88:91], v[48:63]
    s_add_u32 m0, s15, 2048
    s_nop 0
    buffer_load_dwordx4 v192, s[24:27], s11 offen lds
    s_add_u32 s11, s11, 7168
    s_add_u32 m0, s15, 3072
    s_nop 0
    buffer_load_dwordx4 v192, s[24:27], s11 offen lds
    s_add_u32 s11, s11, 7168
    v_mfma_f32_32x32x16_bf16 v[64:79], v[188:191], v[92:95], v[64:79]
    buffer_load_dwordx4 v[88:91], v15, s[40:43], s12 offen offset:1024
    buffer_load_dwordx4 v[92:95], v15, s[40:43], s13 offen offset:1024
    ds_read_b64_tr_b16 v[184:185], v193 offset:6144
    ds_read_b64_tr_b16 v[186:187], v193 offset:7168
    ds_read_b64_tr_b16 v[188:189], v194 offset:6144
    ds_read_b64_tr_b16 v[190:191], v194 offset:7168
    s_waitcnt lgkmcnt(6)
    s_waitcnt vmcnt(27)
    v_mfma_f32_32x32x16_bf16 v[16:31], v[176:179], v[96:99], v[16:31]
    s_waitcnt vmcnt(26)
    v_mfma_f32_32x32x16_bf16 v[32:47], v[176:179], v[100:103], v[32:47]
    s_add_u32 m0, s20, 0
    s_nop 0
    buffer_load_dwordx4 v192, s[28:31], s73 offen lds
    s_add_u32 s73, s73, 7168
    s_waitcnt lgkmcnt(4)
    v_mfma_f32_32x32x16_bf16 v[48:63], v[180:183], v[96:99], v[48:63]
    s_add_u32 m0, s15, 4096
    s_nop 0
    buffer_load_dwordx4 v192, s[24:27], s11 offen lds
    s_add_u32 s11, s11, 7168
    s_add_u32 m0, s15, 5120
    s_nop 0
    buffer_load_dwordx4 v192, s[24:27], s11 offen lds
    s_add_u32 s11, s11, 7168
    v_mfma_f32_32x32x16_bf16 v[64:79], v[180:183], v[100:103], v[64:79]
    buffer_load_dwordx4 v[96:99], v15, s[40:43], s12 offen offset:2048
    buffer_load_dwordx4 v[100:103], v15, s[40:43], s13 offen offset:2048
    ds_read_b64_tr_b16 v[176:177], v193 offset:8192
    ds_read_b64_tr_b16 v[178:179], v193 offset:9216
    ds_read_b64_tr_b16 v[180:181], v194 offset:8192
    ds_read_b64_tr_b16 v[182:183], v194 offset:9216
    s_waitcnt lgkmcnt(6)
    s_waitcnt vmcnt(30)
    v_mfma_f32_32x32x16_bf16 v[16:31], v[184:187], v[104:107], v[16:31]
    s_waitcnt vmcnt(29)
    v_mfma_f32_32x32x16_bf16 v[32:47], v[184:187], v[108:111], v[32:47]
    s_add_u32 m0, s20, 1024
    s_nop 0
    buffer_load_dwordx4 v192, s[28:31], s73 offen lds
    s_add_u32 s73, s73, 7168
    s_waitcnt lgkmcnt(4)
    v_mfma_f32_32x32x16_bf16 v[48:63], v[188:191], v[104:107], v[48:63]
    s_add_u32 m0, s15, 6144
    s_nop 0
    buffer_load_dwordx4 v192, s[24:27], s11 offen lds
    s_add_u32 s11, s11, 7168
    s_add_u32 m0, s15, 7168
    s_nop 0
    buffer_load_dwordx4 v192, s[24:27], s11 offen lds
    s_add_u32 s11, s11, 7168
    v_mfma_f32_32x32x16_bf16 v[64:79], v[188:191], v[108:111], v[64:79]
    buffer_load_dwordx4 v[104:107], v15, s[40:43], s12 offen offset:3072
    buffer_load_dwordx4 v[108:111], v15, s[40:43], s13 offen offset:3072
    s_add_u32 s12, s12, 4096
    s_add_u32 s13, s13, 4096
    ds_read_b64_tr_b16 v[184:185], v193 offset:10240
    ds_read_b64_tr_b16 v[186:187], v193 offset:11264
    ds_read_b64_tr_b16 v[188:189], v194 offset:10240
    ds_read_b64_tr_b16 v[190:191], v194 offset:11264
    s_waitcnt lgkmcnt(6)
    s_waitcnt vmcnt(33)
    v_mfma_f32_32x32x16_bf16 v[16:31], v[176:179], v[112:115], v[16:31]
    s_waitcnt vmcnt(32)
    v_mfma_f32_32x32x16_bf16 v[32:47], v[176:179], v[116:119], v[32:47]
    s_add_u32 m0, s20, 2048
    s_nop 0
    buffer_load_dwordx4 v192, s[28:31], s73 offen lds
    s_add_u32 s73, s73, 7168
    s_waitcnt lgkmcnt(4)
    v_mfma_f32_32x32x16_bf16 v[48:63], v[180:183], v[112:115], v[48:63]
    s_add_u32 m0, s15, 8192
    s_nop 0
    buffer_load_dwordx4 v192, s[24:27], s11 offen lds
    s_add_u32 s11, s11, 7168
    s_add_u32 m0, s15, 9216
    s_nop 0
    buffer_load_dwordx4 v192, s[24:27], s11 offen lds
    s_add_u32 s11, s11, 7168
    v_mfma_f32_32x32x16_bf16 v[64:79], v[180:183], v[116:119], v[64:79]
    buffer_load_dwordx4 v[112:115], v15, s[40:43], s12 offen offset:0
    buffer_load_dwordx4 v[116:119], v15, s[40:43], s13 offen offset:0
    s_waitcnt vmcnt(21)
    ds_read_b64_tr_b16 v[176:177], v193 offset:0
    ds_read_b64_tr_b16 v[178:179], v193 offset:1024
    ds_read_b64_tr_b16 v[180:181], v194 offset:0
    ds_read_b64_tr_b16 v[182:183], v194 offset:1024
    s_waitcnt lgkmcnt(6)
    s_waitcnt vmcnt(36)
    v_mfma_f32_32x32x16_bf16 v[16:31], v[184:187], v[120:123], v[16:31]
    s_waitcnt vmcnt(35)
    v_mfma_f32_32x32x16_bf16 v[32:47], v[184:187], v[124:127], v[32:47]
    s_add_u32 m0, s20, 3072
    s_nop 0
    buffer_load_dwordx4 v192, s[28:31], s73 offen lds
    s_add_u32 s73, s73, 7168
    s_waitcnt lgkmcnt(4)
    v_mfma_f32_32x32x16_bf16 v[48:63], v[188:191], v[120:123], v[48:63]
    s_add_u32 m0, s15, 10240
    s_nop 0
    buffer_load_dwordx4 v192, s[24:27], s11 offen lds
    s_add_u32 s11, s11, 7168
    s_add_u32 m0, s15, 11264
    s_nop 0
    buffer_load_dwordx4 v192, s[24:27], s11 offen lds
    s_add_u32 s11, s11, 7168
    v_mfma_f32_32x32x16_bf16 v[64:79], v[188:191], v[124:127], v[64:79]
    buffer_load_dwordx4 v[120:123], v15, s[40:43], s12 offen offset:1024
    buffer_load_dwordx4 v[124:127], v15, s[40:43], s13 offen offset:1024
    s_waitcnt vmcnt(22)
    ds_read_b64_tr_b16 v[184:185], v193 offset:2048
    ds_read_b64_tr_b16 v[186:187], v193 offset:3072
    ds_read_b64_tr_b16 v[188:189], v194 offset:2048
    ds_read_b64_tr_b16 v[190:191], v194 offset:3072
    s_waitcnt lgkmcnt(6)
    s_waitcnt vmcnt(39)
    v_mfma_f32_32x32x16_bf16 v[16:31], v[176:179], v[128:131], v[16:31]
    s_waitcnt vmcnt(38)
    v_mfma_f32_32x32x16_bf16 v[32:47], v[176:179], v[132:135], v[32:47]
    s_add_u32 m0, s20, 4096
    s_nop 0
    buffer_load_dwordx4 v192, s[28:31], s73 offen lds
    s_add_u32 s73, s73, 7168
    s_waitcnt lgkmcnt(4)
    v_mfma_f32_32x32x16_bf16 v[48:63], v[180:183], v[128:131], v[48:63]
    s_add_u32 m0, s15, 0
    s_nop 0
    buffer_load_dwordx4 v192, s[24:27], s11 offen lds
    s_add_u32 s11, s11, 7168
    s_add_u32 m0, s15, 1024
    s_nop 0
    buffer_load_dwordx4 v192, s[24:27], s11 offen lds
    s_add_u32 s11, s11, 7168
    v_mfma_f32_32x32x16_bf16 v[64:79], v[180:183], v[132:135], v[64:79]
    buffer_load_dwordx4 v[128:131], v15, s[40:43], s12 offen offset:2048
    buffer_load_dwordx4 v[132:135], v15, s[40:43], s13 offen offset:2048
    s_waitcnt vmcnt(22)
    ds_read_b64_tr_b16 v[176:177], v193 offset:4096
    ds_read_b64_tr_b16 v[178:179], v193 offset:5120
    ds_read_b64_tr_b16 v[180:181], v194 offset:4096
    ds_read_b64_tr_b16 v[182:183], v194 offset:5120
    s_waitcnt lgkmcnt(6)
    s_waitcnt vmcnt(42)
    v_mfma_f32_32x32x16_bf16 v[16:31], v[184:187], v[136:139], v[16:31]
    s_waitcnt vmcnt(41)
    v_mfma_f32_32x32x16_bf16 v[32:47], v[184:187], v[140:143], v[32:47]
    s_add_u32 m0, s20, 5120
    s_nop 0
    buffer_load_dwordx4 v192, s[28:31], s73 offen lds
    s_add_u32 s73, s73, 7168
    s_waitcnt lgkmcnt(4)
    v_mfma_f32_32x32x16_bf16 v[48:63], v[188:191], v[136:139], v[48:63]
    s_add_u32 m0, s15, 2048
    s_nop 0
    buffer_load_dwordx4 v192, s[24:27], s11 offen lds
    s_add_u32 s11, s11, 7168
    s_add_u32 m0, s15, 3072
    s_nop 0
    buffer_load_dwordx4 v192, s[24:27], s11 offen lds
    s_add_u32 s11, s11, 7168
    v_mfma_f32_32x32x16_bf16 v[64:79], v[188:191], v[140:143], v[64:79]
    buffer_load_dwordx4 v[136:139], v15, s[40:43], s12 offen offset:3072
    buffer_load_dwordx4 v[140:143], v15, s[40:43], s13 offen offset:3072
    s_add_u32 s12, s12, 4096
    s_add_u32 s13, s13, 4096
    s_waitcnt vmcnt(22)
    ds_read_b64_tr_b16 v[184:185], v193 offset:6144
    ds_read_b64_tr_b16 v[186:187], v193 offset:7168
    ds_read_b64_tr_b16 v[188:189], v194 offset:6144
    ds_read_b64_tr_b16 v[190:191], v194 offset:7168
    s_waitcnt lgkmcnt(6)
    s_waitcnt vmcnt(45)
    v_mfma_f32_32x32x16_bf16 v[16:31], v[176:179], v[144:147], v[16:31]
    s_waitcnt vmcnt(44)
    v_mfma_f32_32x32x16_bf16 v[32:47], v[176:179], v[148:151], v[32:47]
    s_add_u32 m0, s20, 6144
    s_nop 0
    buffer_load_dwordx4 v192, s[28:31], s73 offen lds
    s_add_u32 s73, s73, 7168
    s_waitcnt lgkmcnt(4)
    v_mfma_f32_32x32x16_bf16 v[48:63], v[180:183], v[144:147], v[48:63]
    s_add_u32 m0, s15, 4096
    s_nop 0
    buffer_load_dwordx4 v192, s[24:27], s11 offen lds
    s_add_u32 s11, s11, 7168
    s_add_u32 m0, s15, 5120
    s_nop 0
    buffer_load_dwordx4 v192, s[24:27], s11 offen lds
    s_add_u32 s11, s11, 7168
    v_mfma_f32_32x32x16_bf16 v[64:79], v[180:183], v[148:151], v[64:79]
    buffer_load_dwordx4 v[144:147], v15, s[40:43], s12 offen offset:0
    buffer_load_dwordx4 v[148:151], v15, s[40:43], s13 offen offset:0
    s_waitcnt vmcnt(22)
    ds_read_b64_tr_b16 v[176:177], v193 offset:8192
    ds_read_b64_tr_b16 v[178:179], v193 offset:9216
    ds_read_b64_tr_b16 v[180:181], v194 offset:8192
    ds_read_b64_tr_b16 v[182:183], v194 offset:9216
    s_waitcnt lgkmcnt(6)
    s_waitcnt vmcnt(48)
    v_mfma_f32_32x32x16_bf16 v[16:31], v[184:187], v[152:155], v[16:31]
    s_waitcnt vmcnt(47)
    v_mfma_f32_32x32x16_bf16 v[32:47], v[184:187], v[156:159], v[32:47]
    s_add_u32 m0, s20, 7168
    s_nop 0
    buffer_load_dwordx4 v192, s[28:31], s73 offen lds
    s_add_u32 s73, s73, 7168
    s_waitcnt lgkmcnt(4)
    v_mfma_f32_32x32x16_bf16 v[48:63], v[188:191], v[152:155], v[48:63]
    s_add_u32 m0, s15, 6144
    s_nop 0
    buffer_load_dwordx4 v192, s[24:27], s11 offen lds
    s_add_u32 s11, s11, 7168
    s_add_u32 m0, s15, 7168
    s_nop 0
    buffer_load_dwordx4 v192, s[24:27], s11 offen lds
    s_add_u32 s11, s11, 7168
    v_mfma_f32_32x32x16_bf16 v[64:79], v[188:191], v[156:159], v[64:79]
    buffer_load_dwordx4 v[152:155], v15, s[40:43], s12 offen offset:1024
    buffer_load_dwordx4 v[156:159], v15, s[40:43], s13 offen offset:1024
    s_waitcnt vmcnt(22)
    ds_read_b64_tr_b16 v[184:185], v193 offset:10240
    ds_read_b64_tr_b16 v[186:187], v193 offset:11264
    ds_read_b64_tr_b16 v[188:189], v194 offset:10240
    ds_read_b64_tr_b16 v[190:191], v194 offset:11264
    s_waitcnt lgkmcnt(6)
    s_waitcnt vmcnt(51)
    v_mfma_f32_32x32x16_bf16 v[16:31], v[176:179], v[160:163], v[16:31]
    s_waitcnt vmcnt(50)
    v_mfma_f32_32x32x16_bf16 v[32:47], v[176:179], v[164:167], v[32:47]
    s_add_u32 m0, s20, 8192
    s_nop 0
    buffer_load_dwordx4 v192, s[28:31], s73 offen lds
    s_add_u32 s73, s73, 7168
    s_waitcnt lgkmcnt(4)
    v_mfma_f32_32x32x16_bf16 v[48:63], v[180:183], v[160:163], v[48:63]
    s_add_u32 m0, s15, 8192
    s_nop 0
    buffer_load_dwordx4 v192, s[24:27], s11 offen lds
    s_add_u32 s11, s11, 7168
    s_add_u32 m0, s15, 9216
    s_nop 0
    buffer_load_dwordx4 v192, s[24:27], s11 offen lds
    s_add_u32 s11, s11, 7168
    v_mfma_f32_32x32x16_bf16 v[64:79], v[180:183], v[164:167], v[64:79]
    buffer_load_dwordx4 v[160:163], v15, s[40:43], s12 offen offset:2048
    buffer_load_dwordx4 v[164:167], v15, s[40:43], s13 offen offset:2048
    s_waitcnt vmcnt(22)
    ds_read_b64_tr_b16 v[176:177], v193 offset:0
    ds_read_b64_tr_b16 v[178:179], v193 offset:1024
    ds_read_b64_tr_b16 v[180:181], v194 offset:0
    ds_read_b64_tr_b16 v[182:183], v194 offset:1024
    s_waitcnt lgkmcnt(6)
    s_waitcnt vmcnt(54)
    v_mfma_f32_32x32x16_bf16 v[16:31], v[184:187], v[168:171], v[16:31]
    s_waitcnt vmcnt(53)
    v_mfma_f32_32x32x16_bf16 v[32:47], v[184:187], v[172:175], v[32:47]
    s_add_u32 m0, s20, 9216
    s_nop 0
    buffer_load_dwordx4 v192, s[28:31], s73 offen lds
    s_add_u32 s73, s73, 7168
    s_waitcnt lgkmcnt(4)
    ds_add_u32 v2, v3 offset:16
    v_mfma_f32_32x32x16_bf16 v[48:63], v[188:191], v[168:171], v[48:63]
    s_add_u32 m0, s15, 10240
    s_nop 0
    buffer_load_dwordx4 v192, s[24:27], s11 offen lds
    s_add_u32 s11, s11, 7168
    s_add_u32 m0, s15, 11264
    s_nop 0
    buffer_load_dwordx4 v192, s[24:27], s11 offen lds
    s_add_u32 s11, s11, 7168
    v_mfma_f32_32x32x16_bf16 v[64:79], v[188:191], v[172:175], v[64:79]
    buffer_load_dwordx4 v[168:171], v15, s[40:43], s12 offen offset:3072
    buffer_load_dwordx4 v[172:175], v15, s[40:43], s13 offen offset:3072
    s_add_u32 s12, s12, 4096
    s_add_u32 s13, s13, 4096
    s_waitcnt vmcnt(22)
    ds_read_b64_tr_b16 v[184:185], v193 offset:2048
    ds_read_b64_tr_b16 v[186:187], v193 offset:3072
    ds_read_b64_tr_b16 v[188:189], v194 offset:2048
    ds_read_b64_tr_b16 v[190:191], v194 offset:3072
    s_waitcnt lgkmcnt(7)
    s_waitcnt vmcnt(55)
    v_mfma_f32_32x32x16_bf16 v[16:31], v[176:179], v[80:83], v[16:31]
    s_waitcnt vmcnt(54)
    v_mfma_f32_32x32x16_bf16 v[32:47], v[176:179], v[84:87], v[32:47]
    s_add_u32 m0, s20, 10240
    s_nop 0
    buffer_load_dwordx4 v192, s[28:31], s73 offen lds
    s_add_u32 s73, s73, 7168
    s_waitcnt lgkmcnt(5)
    v_mfma_f32_32x32x16_bf16 v[48:63], v[180:183], v[80:83], v[48:63]
    s_add_u32 m0, s15, 0
    s_nop 0
    buffer_load_dwordx4 v192, s[24:27], s11 offen lds
    s_add_u32 s11, s11, 7168
    s_add_u32 m0, s15, 1024
    s_nop 0
    buffer_load_dwordx4 v192, s[24:27], s11 offen lds
    s_add_u32 s11, s11, 7168
    v_mfma_f32_32x32x16_bf16 v[64:79], v[180:183], v[84:87], v[64:79]
    buffer_load_dwordx4 v[80:83], v15, s[40:43], s12 offen offset:0
    buffer_load_dwordx4 v[84:87], v15, s[40:43], s13 offen offset:0
    s_waitcnt vmcnt(22)
    ds_read_b64_tr_b16 v[176:177], v193 offset:4096
    ds_read_b64_tr_b16 v[178:179], v193 offset:5120
    ds_read_b64_tr_b16 v[180:181], v194 offset:4096
    ds_read_b64_tr_b16 v[182:183], v194 offset:5120
    s_waitcnt lgkmcnt(6)
    s_waitcnt vmcnt(56)
    v_mfma_f32_32x32x16_bf16 v[16:31], v[184:187], v[88:91], v[16:31]
    s_waitcnt vmcnt(55)
    v_mfma_f32_32x32x16_bf16 v[32:47], v[184:187], v[92:95], v[32:47]
    s_add_u32 m0, s20, 11264
    s_nop 0
    buffer_load_dwordx4 v192, s[28:31], s73 offen lds
    s_add_u32 s73, s73, 7168
    s_waitcnt lgkmcnt(4)
    v_mfma_f32_32x32x16_bf16 v[48:63], v[188:191], v[88:91], v[48:63]
    s_add_u32 m0, s15, 2048
    s_nop 0
    buffer_load_dwordx4 v192, s[24:27], s11 offen lds
    s_add_u32 s11, s11, 7168
    s_add_u32 m0, s15, 3072
    s_nop 0
    buffer_load_dwordx4 v192, s[24:27], s11 offen lds
    s_add_u32 s11, s11, 7168
    v_mfma_f32_32x32x16_bf16 v[64:79], v[188:191], v[92:95], v[64:79]
    buffer_load_dwordx4 v[88:91], v15, s[40:43], s12 offen offset:1024
    buffer_load_dwordx4 v[92:95], v15, s[40:43], s13 offen offset:1024
    s_waitcnt vmcnt(22)
    ds_read_b64_tr_b16 v[184:185], v193 offset:6144
    ds_read_b64_tr_b16 v[186:187], v193 offset:7168
    ds_read_b64_tr_b16 v[188:189], v194 offset:6144
    ds_read_b64_tr_b16 v[190:191], v194 offset:7168
    s_waitcnt lgkmcnt(6)
    s_waitcnt vmcnt(56)
    v_mfma_f32_32x32x16_bf16 v[16:31], v[176:179], v[96:99], v[16:31]
    s_waitcnt vmcnt(55)
    v_mfma_f32_32x32x16_bf16 v[32:47], v[176:179], v[100:103], v[32:47]
    s_add_u32 m0, s20, 12288
    s_nop 0
    buffer_load_dwordx4 v192, s[28:31], s73 offen lds
    s_add_u32 s73, s73, 7168
    s_waitcnt lgkmcnt(4)
    v_mfma_f32_32x32x16_bf16 v[48:63], v[180:183], v[96:99], v[48:63]
    s_add_u32 m0, s15, 4096
    s_nop 0
    buffer_load_dwordx4 v192, s[24:27], s11 offen lds
    s_add_u32 s11, s11, 7168
    s_add_u32 m0, s15, 5120
    s_nop 0
    buffer_load_dwordx4 v192, s[24:27], s11 offen lds
    s_add_u32 s11, s11, 7168
    v_mfma_f32_32x32x16_bf16 v[64:79], v[180:183], v[100:103], v[64:79]
    buffer_load_dwordx4 v[96:99], v15, s[40:43], s12 offen offset:2048
    buffer_load_dwordx4 v[100:103], v15, s[40:43], s13 offen offset:2048
    s_waitcnt vmcnt(22)
    ds_read_b64_tr_b16 v[176:177], v193 offset:8192
    ds_read_b64_tr_b16 v[178:179], v193 offset:9216
    ds_read_b64_tr_b16 v[180:181], v194 offset:8192
    ds_read_b64_tr_b16 v[182:183], v194 offset:9216
    s_waitcnt lgkmcnt(6)
    s_waitcnt vmcnt(56)
    v_mfma_f32_32x32x16_bf16 v[16:31], v[184:187], v[104:107], v[16:31]
    s_waitcnt vmcnt(55)
    v_mfma_f32_32x32x16_bf16 v[32:47], v[184:187], v[108:111], v[32:47]
    s_add_u32 m0, s20, 13312
    s_nop 0
    buffer_load_dwordx4 v192, s[28:31], s73 offen lds
    s_add_u32 s73, s73, 7168
    s_waitcnt lgkmcnt(4)
    v_mfma_f32_32x32x16_bf16 v[48:63], v[188:191], v[104:107], v[48:63]
    s_add_u32 m0, s15, 6144
    s_nop 0
    buffer_load_dwordx4 v192, s[24:27], s11 offen lds
    s_add_u32 s11, s11, 7168
    s_add_u32 m0, s15, 7168
    s_nop 0
    buffer_load_dwordx4 v192, s[24:27], s11 offen lds
    s_add_u32 s11, s11, 7168
    v_mfma_f32_32x32x16_bf16 v[64:79], v[188:191], v[108:111], v[64:79]
    buffer_load_dwordx4 v[104:107], v15, s[40:43], s12 offen offset:3072
    buffer_load_dwordx4 v[108:111], v15, s[40:43], s13 offen offset:3072
    s_add_u32 s12, s12, 4096
    s_add_u32 s13, s13, 4096
    s_waitcnt vmcnt(22)
    ds_read_b64_tr_b16 v[184:185], v193 offset:10240
    ds_read_b64_tr_b16 v[186:187], v193 offset:11264
    ds_read_b64_tr_b16 v[188:189], v194 offset:10240
    ds_read_b64_tr_b16 v[190:191], v194 offset:11264
    s_waitcnt lgkmcnt(6)
    s_waitcnt vmcnt(56)
    v_mfma_f32_32x32x16_bf16 v[16:31], v[176:179], v[112:115], v[16:31]
    s_waitcnt vmcnt(55)
    v_mfma_f32_32x32x16_bf16 v[32:47], v[176:179], v[116:119], v[32:47]
    s_cmp_eq_u32 s58, 3
    s_cselect_b32 s74, 7168, 0
    s_sub_u32 s73, s73, s74
    s_add_u32 m0, s20, 14336
    s_nop 0
    buffer_load_dwordx4 v192, s[28:31], s73 offen lds
    s_add_u32 s73, s73, 7168
    s_waitcnt lgkmcnt(4)
    v_mfma_f32_32x32x16_bf16 v[48:63], v[180:183], v[112:115], v[48:63]
    s_add_u32 m0, s15, 8192
    s_nop 0
    buffer_load_dwordx4 v192, s[24:27], s11 offen lds
    s_add_u32 s11, s11, 7168
    s_add_u32 m0, s15, 9216
    s_nop 0
    buffer_load_dwordx4 v192, s[24:27], s11 offen lds
    s_add_u32 s11, s11, 7168
    v_mfma_f32_32x32x16_bf16 v[64:79], v[180:183], v[116:119], v[64:79]
    s_waitcnt vmcnt(20)
    ds_read_b64_tr_b16 v[176:177], v193 offset:0
    ds_read_b64_tr_b16 v[178:179], v193 offset:1024
    ds_read_b64_tr_b16 v[180:181], v194 offset:0
    ds_read_b64_tr_b16 v[182:183], v194 offset:1024
    s_waitcnt lgkmcnt(6)
    s_waitcnt vmcnt(54)
    v_mfma_f32_32x32x16_bf16 v[16:31], v[184:187], v[120:123], v[16:31]
    s_waitcnt vmcnt(53)
    v_mfma_f32_32x32x16_bf16 v[32:47], v[184:187], v[124:127], v[32:47]
    s_waitcnt lgkmcnt(4)
    v_mfma_f32_32x32x16_bf16 v[48:63], v[188:191], v[120:123], v[48:63]
    s_add_u32 m0, s15, 10240
    s_nop 0
    buffer_load_dwordx4 v192, s[24:27], s11 offen lds
    s_add_u32 s11, s11, 7168
    s_add_u32 m0, s15, 11264
    s_nop 0
    buffer_load_dwordx4 v192, s[24:27], s11 offen lds
    s_add_u32 s11, s11, 7168
    v_mfma_f32_32x32x16_bf16 v[64:79], v[188:191], v[124:127], v[64:79]
    s_waitcnt vmcnt(17)
    ds_read_b64_tr_b16 v[184:185], v193 offset:2048
    ds_read_b64_tr_b16 v[186:187], v193 offset:3072
    ds_read_b64_tr_b16 v[188:189], v194 offset:2048
    ds_read_b64_tr_b16 v[190:191], v194 offset:3072
    s_waitcnt lgkmcnt(6)
    s_waitcnt vmcnt(51)
    v_mfma_f32_32x32x16_bf16 v[16:31], v[176:179], v[128:131], v[16:31]
    s_waitcnt vmcnt(50)
    v_mfma_f32_32x32x16_bf16 v[32:47], v[176:179], v[132:135], v[32:47]
    s_waitcnt lgkmcnt(4)
    v_mfma_f32_32x32x16_bf16 v[48:63], v[180:183], v[128:131], v[48:63]
    s_add_u32 m0, s15, 0
    s_nop 0
    buffer_load_dwordx4 v192, s[24:27], s11 offen lds
    s_add_u32 s11, s11, 7168
    s_add_u32 m0, s15, 1024
    s_nop 0
    buffer_load_dwordx4 v192, s[24:27], s11 offen lds
    s_add_u32 s11, s11, 7168
    ds_read_b64_tr_b16 v[112:113], v250 offset:0
    ds_read_b64_tr_b16 v[114:115], v250 offset:1024
    ds_read_b64_tr_b16 v[116:117], v251 offset:0
    ds_read_b64_tr_b16 v[118:119], v251 offset:1024
    v_mfma_f32_32x32x16_bf16 v[64:79], v[180:183], v[132:135], v[64:79]
    s_waitcnt vmcnt(14)
    ds_read_b64_tr_b16 v[176:177], v193 offset:4096
    ds_read_b64_tr_b16 v[178:179], v193 offset:5120
    ds_read_b64_tr_b16 v[180:181], v194 offset:4096
    ds_read_b64_tr_b16 v[182:183], v194 offset:5120
    s_waitcnt lgkmcnt(10)
    s_waitcnt vmcnt(48)
    v_mfma_f32_32x32x16_bf16 v[16:31], v[184:187], v[136:139], v[16:31]
    s_waitcnt vmcnt(47)
    v_mfma_f32_32x32x16_bf16 v[32:47], v[184:187], v[140:143], v[32:47]
    s_waitcnt lgkmcnt(8)
    v_mfma_f32_32x32x16_bf16 v[48:63], v[188:191], v[136:139], v[48:63]
    s_add_u32 m0, s15, 2048
    s_nop 0
    buffer_load_dwordx4 v192, s[24:27], s11 offen lds
    s_add_u32 s11, s11, 7168
    s_add_u32 m0, s15, 3072
    s_nop 0
    buffer_load_dwordx4 v192, s[24:27], s11 offen lds
    s_add_u32 s11, s11, 7168
    ds_read_b64_tr_b16 v[120:121], v250 offset:2048
    ds_read_b64_tr_b16 v[122:123], v250 offset:3072
    ds_read_b64_tr_b16 v[124:125], v251 offset:2048
    ds_read_b64_tr_b16 v[126:127], v251 offset:3072
    v_mfma_f32_32x32x16_bf16 v[64:79], v[188:191], v[140:143], v[64:79]
    s_waitcnt vmcnt(11)
    ds_read_b64_tr_b16 v[184:185], v193 offset:6144
    ds_read_b64_tr_b16 v[186:187], v193 offset:7168
    ds_read_b64_tr_b16 v[188:189], v194 offset:6144
    ds_read_b64_tr_b16 v[190:191], v194 offset:7168
    s_waitcnt lgkmcnt(10)
    s_waitcnt vmcnt(45)
    v_mfma_f32_32x32x16_bf16 v[16:31], v[176:179], v[144:147], v[16:31]
    s_waitcnt vmcnt(44)
    v_mfma_f32_32x32x16_bf16 v[32:47], v[176:179], v[148:151], v[32:47]
    s_waitcnt lgkmcnt(8)
    v_mfma_f32_32x32x16_bf16 v[48:63], v[180:183], v[144:147], v[48:63]
    s_add_u32 m0, s15, 4096
    s_nop 0
    buffer_load_dwordx4 v192, s[24:27], s11 offen lds
    s_add_u32 s11, s11, 7168
    s_add_u32 m0, s15, 5120
    s_nop 0
    buffer_load_dwordx4 v192, s[24:27], s11 offen lds
    s_add_u32 s11, s11, 7168
    ds_read_b64_tr_b16 v[128:129], v250 offset:3584
    ds_read_b64_tr_b16 v[130:131], v250 offset:4608
    ds_read_b64_tr_b16 v[132:133], v251 offset:3584
    ds_read_b64_tr_b16 v[134:135], v251 offset:4608
    v_mfma_f32_32x32x16_bf16 v[64:79], v[180:183], v[148:151], v[64:79]
    s_waitcnt vmcnt(8)
    ds_read_b64_tr_b16 v[176:177], v193 offset:8192
    ds_read_b64_tr_b16 v[178:179], v193 offset:9216
    ds_read_b64_tr_b16 v[180:181], v194 offset:8192
    ds_read_b64_tr_b16 v[182:183], v194 offset:9216
    s_waitcnt lgkmcnt(10)
    s_waitcnt vmcnt(42)
    v_mfma_f32_32x32x16_bf16 v[16:31], v[184:187], v[152:155], v[16:31]
    s_waitcnt vmcnt(41)
    v_mfma_f32_32x32x16_bf16 v[32:47], v[184:187], v[156:159], v[32:47]
    s_waitcnt lgkmcnt(8)
    v_mfma_f32_32x32x16_bf16 v[48:63], v[188:191], v[152:155], v[48:63]
    s_add_u32 m0, s15, 6144
    s_nop 0
    buffer_load_dwordx4 v192, s[24:27], s11 offen lds
    s_add_u32 s11, s11, 7168
    s_add_u32 m0, s15, 7168
    s_nop 0
    buffer_load_dwordx4 v192, s[24:27], s11 offen lds
    s_add_u32 s11, s11, 7168
    ds_read_b64_tr_b16 v[136:137], v250 offset:5632
    ds_read_b64_tr_b16 v[138:139], v250 offset:6656
    ds_read_b64_tr_b16 v[140:141], v251 offset:5632
    ds_read_b64_tr_b16 v[142:143], v251 offset:6656
    v_mfma_f32_32x32x16_bf16 v[64:79], v[188:191], v[156:159], v[64:79]
    s_waitcnt vmcnt(8)
    ds_read_b64_tr_b16 v[184:185], v193 offset:10240
    ds_read_b64_tr_b16 v[186:187], v193 offset:11264
    ds_read_b64_tr_b16 v[188:189], v194 offset:10240
    ds_read_b64_tr_b16 v[190:191], v194 offset:11264
    s_waitcnt lgkmcnt(10)
    s_waitcnt vmcnt(39)
    v_mfma_f32_32x32x16_bf16 v[16:31], v[176:179], v[160:163], v[16:31]
    s_waitcnt vmcnt(38)
    v_mfma_f32_32x32x16_bf16 v[32:47], v[176:179], v[164:167], v[32:47]
    s_waitcnt lgkmcnt(8)
    v_mfma_f32_32x32x16_bf16 v[48:63], v[180:183], v[160:163], v[48:63]
    ds_read_b64_tr_b16 v[144:145], v250 offset:7168
    ds_read_b64_tr_b16 v[146:147], v250 offset:8192
    ds_read_b64_tr_b16 v[148:149], v251 offset:7168
    ds_read_b64_tr_b16 v[150:151], v251 offset:8192
    v_mfma_f32_32x32x16_bf16 v[64:79], v[180:183], v[164:167], v[64:79]
    s_waitcnt vmcnt(6)
    ds_read_b64_tr_b16 v[176:177], v193 offset:0
    ds_read_b64_tr_b16 v[178:179], v193 offset:1024
    ds_read_b64_tr_b16 v[180:181], v194 offset:0
    ds_read_b64_tr_b16 v[182:183], v194 offset:1024
    s_waitcnt lgkmcnt(10)
    s_waitcnt vmcnt(34)
    v_mfma_f32_32x32x16_bf16 v[16:31], v[184:187], v[168:171], v[16:31]
    s_waitcnt vmcnt(33)
    v_mfma_f32_32x32x16_bf16 v[32:47], v[184:187], v[172:175], v[32:47]
    s_waitcnt lgkmcnt(8)
    v_mfma_f32_32x32x16_bf16 v[48:63], v[188:191], v[168:171], v[48:63]
    ds_read_b64_tr_b16 v[152:153], v250 offset:9216
    ds_read_b64_tr_b16 v[154:155], v250 offset:10240
    ds_read_b64_tr_b16 v[156:157], v251 offset:9216
    ds_read_b64_tr_b16 v[158:159], v251 offset:10240
    v_mfma_f32_32x32x16_bf16 v[64:79], v[188:191], v[172:175], v[64:79]
    s_waitcnt vmcnt(4)
    ds_read_b64_tr_b16 v[184:185], v193 offset:2048
    ds_read_b64_tr_b16 v[186:187], v193 offset:3072
    ds_read_b64_tr_b16 v[188:189], v194 offset:2048
    ds_read_b64_tr_b16 v[190:191], v194 offset:3072
    s_waitcnt lgkmcnt(10)
    s_waitcnt vmcnt(29)
    v_mfma_f32_32x32x16_bf16 v[16:31], v[176:179], v[80:83], v[16:31]
    s_waitcnt vmcnt(28)
    v_mfma_f32_32x32x16_bf16 v[32:47], v[176:179], v[84:87], v[32:47]
    s_waitcnt lgkmcnt(8)
    v_mfma_f32_32x32x16_bf16 v[48:63], v[180:183], v[80:83], v[48:63]
    ds_read_b64_tr_b16 v[160:161], v250 offset:10752
    ds_read_b64_tr_b16 v[162:163], v250 offset:11776
    ds_read_b64_tr_b16 v[164:165], v251 offset:10752
    ds_read_b64_tr_b16 v[166:167], v251 offset:11776
    v_mfma_f32_32x32x16_bf16 v[64:79], v[180:183], v[84:87], v[64:79]
    s_waitcnt vmcnt(2)
    ds_read_b64_tr_b16 v[176:177], v193 offset:4096
    ds_read_b64_tr_b16 v[178:179], v193 offset:5120
    ds_read_b64_tr_b16 v[180:181], v194 offset:4096
    ds_read_b64_tr_b16 v[182:183], v194 offset:5120
    s_waitcnt lgkmcnt(10)
    s_waitcnt vmcnt(24)
    v_mfma_f32_32x32x16_bf16 v[16:31], v[184:187], v[88:91], v[16:31]
    s_waitcnt vmcnt(23)
    v_mfma_f32_32x32x16_bf16 v[32:47], v[184:187], v[92:95], v[32:47]
    s_waitcnt lgkmcnt(8)
    v_mfma_f32_32x32x16_bf16 v[48:63], v[188:191], v[88:91], v[48:63]
    ds_read_b64_tr_b16 v[168:169], v250 offset:12800
    ds_read_b64_tr_b16 v[170:171], v250 offset:13824
    ds_read_b64_tr_b16 v[172:173], v251 offset:12800
    ds_read_b64_tr_b16 v[174:175], v251 offset:13824
    v_mfma_f32_32x32x16_bf16 v[64:79], v[188:191], v[92:95], v[64:79]
    s_waitcnt vmcnt(0)
    ds_read_b64_tr_b16 v[184:185], v193 offset:6144
    ds_read_b64_tr_b16 v[186:187], v193 offset:7168
    ds_read_b64_tr_b16 v[188:189], v194 offset:6144
    ds_read_b64_tr_b16 v[190:191], v194 offset:7168
    s_waitcnt lgkmcnt(10)
    s_waitcnt vmcnt(19)
    v_mfma_f32_32x32x16_bf16 v[16:31], v[176:179], v[96:99], v[16:31]
    s_waitcnt vmcnt(18)
    v_mfma_f32_32x32x16_bf16 v[32:47], v[176:179], v[100:103], v[32:47]
    s_waitcnt lgkmcnt(8)
    v_mfma_f32_32x32x16_bf16 v[48:63], v[180:183], v[96:99], v[48:63]
    v_mfma_f32_32x32x16_bf16 v[64:79], v[180:183], v[100:103], v[64:79]
    s_waitcnt lgkmcnt(2)
    s_waitcnt vmcnt(14)
    v_mfma_f32_32x32x16_bf16 v[16:31], v[184:187], v[104:107], v[16:31]
    s_waitcnt vmcnt(13)
    v_mfma_f32_32x32x16_bf16 v[32:47], v[184:187], v[108:111], v[32:47]
    s_waitcnt lgkmcnt(0)
    v_mfma_f32_32x32x16_bf16 v[48:63], v[188:191], v[104:107], v[48:63]
    v_mfma_f32_32x32x16_bf16 v[64:79], v[188:191], v[108:111], v[64:79]
    s_mul_i32 s73, s58, 12288
    s_add_u32 s73, s73, 110592
    v_add_u32 v246, s73, v15
    s_nop 5
    ds_write_b128 v246, v[32:35] offset:0
    ds_write_b128 v246, v[36:39] offset:1024
    ds_write_b128 v246, v[40:43] offset:2048
    ds_write_b128 v246, v[44:47] offset:3072
    ds_write_b128 v246, v[48:51] offset:4096
    ds_write_b128 v246, v[52:55] offset:5120
    ds_write_b128 v246, v[56:59] offset:6144
    ds_write_b128 v246, v[60:63] offset:7168
    ds_write_b128 v246, v[64:67] offset:8192
    ds_write_b128 v246, v[68:71] offset:9216
    ds_write_b128 v246, v[72:75] offset:10240
    ds_write_b128 v246, v[76:79] offset:11264
    ds_add_u32 v2, v3 offset:24
    s_xor_b32 s73, s58, 1
    s_mul_i32 s73, s73, 12288
    s_add_u32 s73, s73, 110592
    v_add_u32 v247, s73, v15
    s_xor_b32 s73, s58, 2
    s_mul_i32 s73, s73, 12288
    s_add_u32 s73, s73, 114688
    v_add_u32 v248, s73, v15
    s_xor_b32 s73, s58, 3
    s_mul_i32 s73, s73, 12288
    s_add_u32 s73, s73, 118784
    v_add_u32 v249, s73, v15
    s_lshl_b32 s77, s7, 14
    s_lshl_b32 s74, s10, 8
    s_add_u32 s77, s77, s74
    s_lshr_b32 s74, s58, 1
    s_lshl_b32 s74, s74, 7
    s_add_u32 s77, s77, s74
    s_add_u32 s77, s77, 17039360
    v_and_b32 v252, 7, v1
    v_lshlrev_b32 v252, 2, v252
    s_bitcmp1_b32 s58, 0
    s_cselect_b32 s74, -1, 1
    s_mul_i32 s74, s74, 15360
    v_add_u32 v240, s74, v250
    v_add_u32 v241, s74, v251
    v_permlane32_swap_b32 v224, v226
    v_permlane32_swap_b32 v225, v227
    v_permlane32_swap_b32 v228, v230
    v_permlane32_swap_b32 v229, v231
    v_lshlrev_b32 v208, 16, v224
    v_and_b32 v209, 0xffff0000, v224
    v_lshlrev_b32 v210, 16, v225
    v_and_b32 v211, 0xffff0000, v225
    v_lshlrev_b32 v212, 16, v226
    v_and_b32 v213, 0xffff0000, v226
    v_lshlrev_b32 v214, 16, v227
    v_and_b32 v215, 0xffff0000, v227
    v_lshlrev_b32 v216, 16, v228
    v_and_b32 v217, 0xffff0000, v228
    v_lshlrev_b32 v218, 16, v229
    v_and_b32 v219, 0xffff0000, v229
    v_lshlrev_b32 v220, 16, v230
    v_and_b32 v221, 0xffff0000, v230
    v_lshlrev_b32 v222, 16, v231
    v_and_b32 v223, 0xffff0000, v231
    s_lshl_b32 s12, s10, 15
    s_lshl_b32 s74, s58, 13
    s_add_u32 s12, s12, s74
    s_add_u32 s12, s12, 14680064
    s_xor_b32 s13, s12, 8192
    s_add_u32 s75, s12, 4096
    s_add_u32 s76, s13, 4096
    s_mov_b32 s96, 0
sw_49:
    ds_read_b32 v246, v6 offset:24
    s_add_u32 s96, s96, 1
    s_waitcnt lgkmcnt(0)
    v_readfirstlane_b32 s97, v246
    s_nop 1
    s_cmp_ge_u32 s97, 4
    s_cbranch_scc1 ok_48
    s_cmp_ge_u32 s96, 160000
    s_cbranch_scc1 ok_48
    s_sleep 1
    s_branch sw_49
ok_48:
    ds_read_b32 v246, v6 offset:4
    v_mov_b32 v253, 0
    ds_read_b128 v[80:83], v247 offset:0
    ds_read_b128 v[84:87], v247 offset:1024
    ds_read_b128 v[88:91], v247 offset:2048
    ds_read_b128 v[92:95], v247 offset:3072
    ds_read_b128 v[96:99], v248 offset:0
    ds_read_b128 v[100:103], v248 offset:1024
    ds_read_b128 v[104:107], v248 offset:2048
    ds_read_b128 v[108:111], v248 offset:3072
    ds_read_b128 v[176:179], v249 offset:0
    ds_read_b128 v[180:183], v249 offset:1024
    ds_read_b128 v[184:187], v249 offset:2048
    ds_read_b128 v[188:191], v249 offset:3072
    s_waitcnt lgkmcnt(11)
    v_pk_add_f32 v[16:17], v[16:17], v[80:81] op_sel_hi:[1,1]
    v_pk_add_f32 v[18:19], v[18:19], v[82:83] op_sel_hi:[1,1]
    s_waitcnt lgkmcnt(10)
    v_pk_add_f32 v[20:21], v[20:21], v[84:85] op_sel_hi:[1,1]
    v_pk_add_f32 v[22:23], v[22:23], v[86:87] op_sel_hi:[1,1]
    s_waitcnt lgkmcnt(9)
    v_pk_add_f32 v[24:25], v[24:25], v[88:89] op_sel_hi:[1,1]
    v_pk_add_f32 v[26:27], v[26:27], v[90:91] op_sel_hi:[1,1]
    s_waitcnt lgkmcnt(8)
    v_pk_add_f32 v[28:29], v[28:29], v[92:93] op_sel_hi:[1,1]
    v_pk_add_f32 v[30:31], v[30:31], v[94:95] op_sel_hi:[1,1]
    s_waitcnt lgkmcnt(7)
    v_pk_add_f32 v[16:17], v[16:17], v[96:97] op_sel_hi:[1,1]
    v_pk_add_f32 v[18:19], v[18:19], v[98:99] op_sel_hi:[1,1]
    s_waitcnt lgkmcnt(6)
    v_pk_add_f32 v[20:21], v[20:21], v[100:101] op_sel_hi:[1,1]
    v_pk_add_f32 v[22:23], v[22:23], v[102:103] op_sel_hi:[1,1]
    s_waitcnt lgkmcnt(5)
    v_pk_add_f32 v[24:25], v[24:25], v[104:105] op_sel_hi:[1,1]
    v_pk_add_f32 v[26:27], v[26:27], v[106:107] op_sel_hi:[1,1]
    s_waitcnt lgkmcnt(4)
    v_pk_add_f32 v[28:29], v[28:29], v[108:109] op_sel_hi:[1,1]
    v_pk_add_f32 v[30:31], v[30:31], v[110:111] op_sel_hi:[1,1]
    s_waitcnt lgkmcnt(3)
    v_pk_add_f32 v[16:17], v[16:17], v[176:177] op_sel_hi:[1,1]
    v_pk_add_f32 v[18:19], v[18:19], v[178:179] op_sel_hi:[1,1]
    s_waitcnt lgkmcnt(2)
    v_pk_add_f32 v[20:21], v[20:21], v[180:181] op_sel_hi:[1,1]
    v_pk_add_f32 v[22:23], v[22:23], v[182:183] op_sel_hi:[1,1]
    s_waitcnt lgkmcnt(1)
    v_pk_add_f32 v[24:25], v[24:25], v[184:185] op_sel_hi:[1,1]
    v_pk_add_f32 v[26:27], v[26:27], v[186:187] op_sel_hi:[1,1]
    s_waitcnt lgkmcnt(0)
    v_pk_add_f32 v[28:29], v[28:29], v[188:189] op_sel_hi:[1,1]
    v_pk_add_f32 v[30:31], v[30:31], v[190:191] op_sel_hi:[1,1]
    v_readfirstlane_b32 s97, v246
    s_nop 1
    s_cmp_ge_u32 s97, 4
    s_cbranch_scc0 fz_oel
    buffer_load_dword v253, v252, s[40:43], s77 offen sc1
fz_oel:
    ds_read_b64_tr_b16 v[48:49], v240 offset:0
    ds_read_b64_tr_b16 v[50:51], v240 offset:1024
    ds_read_b64_tr_b16 v[52:53], v241 offset:0
    ds_read_b64_tr_b16 v[54:55], v241 offset:1024
    ds_read_b64_tr_b16 v[56:57], v240 offset:2048
    ds_read_b64_tr_b16 v[58:59], v240 offset:3072
    ds_read_b64_tr_b16 v[60:61], v241 offset:2048
    ds_read_b64_tr_b16 v[62:63], v241 offset:3072
    ds_read_b64_tr_b16 v[64:65], v240 offset:3584
    ds_read_b64_tr_b16 v[66:67], v240 offset:4608
    ds_read_b64_tr_b16 v[68:69], v241 offset:3584
    ds_read_b64_tr_b16 v[70:71], v241 offset:4608
    ds_read_b64_tr_b16 v[72:73], v240 offset:5632
    ds_read_b64_tr_b16 v[74:75], v240 offset:6656
    ds_read_b64_tr_b16 v[76:77], v241 offset:5632
    ds_read_b64_tr_b16 v[78:79], v241 offset:6656
    s_lshl_b32 s74, s58, 12
    v_add_u32 v242, s74, v15
    v_xor_b32 v243, 8192, v242
    s_and_b32 s74, s58, 1
    s_lshl_b32 s74, s74, 6
    v_add_u32 v244, s74, v2
    v_add_u32 v245, s74, v6
    v_mul_f32 v224, 0xbfb8aa3b, v16
    v_mul_f32 v225, 0xbfb8aa3b, v17
    v_mul_f32 v226, 0xbfb8aa3b, v18
    v_mul_f32 v227, 0xbfb8aa3b, v19
    v_mul_f32 v228, 0xbfb8aa3b, v20
    v_mul_f32 v229, 0xbfb8aa3b, v21
    v_mul_f32 v230, 0xbfb8aa3b, v22
    v_mul_f32 v231, 0xbfb8aa3b, v23
    v_mul_f32 v232, 0xbfb8aa3b, v24
    v_mul_f32 v233, 0xbfb8aa3b, v25
    v_mul_f32 v234, 0xbfb8aa3b, v26
    v_mul_f32 v235, 0xbfb8aa3b, v27
    v_mul_f32 v236, 0xbfb8aa3b, v28
    v_mul_f32 v237, 0xbfb8aa3b, v29
    v_mul_f32 v238, 0xbfb8aa3b, v30
    v_mul_f32 v239, 0xbfb8aa3b, v31
    v_exp_f32 v224, v224
    v_exp_f32 v225, v225
    v_exp_f32 v226, v226
    v_exp_f32 v227, v227
    v_exp_f32 v228, v228
    v_exp_f32 v229, v229
    v_exp_f32 v230, v230
    v_exp_f32 v231, v231
    v_exp_f32 v232, v232
    v_exp_f32 v233, v233
    v_exp_f32 v234, v234
    v_exp_f32 v235, v235
    v_exp_f32 v236, v236
    v_exp_f32 v237, v237
    v_exp_f32 v238, v238
    v_exp_f32 v239, v239
    v_add_f32 v224, 1.0, v224
    v_add_f32 v225, 1.0, v225
    v_add_f32 v226, 1.0, v226
    v_add_f32 v227, 1.0, v227
    v_add_f32 v228, 1.0, v228
    v_add_f32 v229, 1.0, v229
    v_add_f32 v230, 1.0, v230
    v_add_f32 v231, 1.0, v231
    v_add_f32 v232, 1.0, v232
    v_add_f32 v233, 1.0, v233
    v_add_f32 v234, 1.0, v234
    v_add_f32 v235, 1.0, v235
    v_add_f32 v236, 1.0, v236
    v_add_f32 v237, 1.0, v237
    v_add_f32 v238, 1.0, v238
    v_add_f32 v239, 1.0, v239
    v_rcp_f32 v224, v224
    v_rcp_f32 v225, v225
    v_rcp_f32 v226, v226
    v_rcp_f32 v227, v227
    v_rcp_f32 v228, v228
    v_rcp_f32 v229, v229
    v_rcp_f32 v230, v230
    v_rcp_f32 v231, v231
    v_rcp_f32 v232, v232
    v_rcp_f32 v233, v233
    v_rcp_f32 v234, v234
    v_rcp_f32 v235, v235
    v_rcp_f32 v236, v236
    v_rcp_f32 v237, v237
    v_rcp_f32 v238, v238
    v_rcp_f32 v239, v239
    v_pk_mul_f32 v[224:225], v[224:225], v[16:17] op_sel_hi:[1,1]
    v_pk_mul_f32 v[226:227], v[226:227], v[18:19] op_sel_hi:[1,1]
    v_pk_mul_f32 v[228:229], v[228:229], v[20:21] op_sel_hi:[1,1]
    v_pk_mul_f32 v[230:231], v[230:231], v[22:23] op_sel_hi:[1,1]
    v_pk_mul_f32 v[232:233], v[232:233], v[24:25] op_sel_hi:[1,1]
    v_pk_mul_f32 v[234:235], v[234:235], v[26:27] op_sel_hi:[1,1]
    v_pk_mul_f32 v[236:237], v[236:237], v[28:29] op_sel_hi:[1,1]
    v_pk_mul_f32 v[238:239], v[238:239], v[30:31] op_sel_hi:[1,1]
    s_setprio 3
    s_waitcnt vmcnt(0)
    v_cmp_ne_u32 vcc, 1, v253
    s_nop 4
    s_cbranch_vccz fz_opk
    s_mov_b32 s96, 0
sw_51:
    ds_read_b32 v246, v6 offset:4
    s_add_u32 s96, s96, 1
    s_waitcnt lgkmcnt(0)
    v_readfirstlane_b32 s97, v246
    s_nop 1
    s_cmp_ge_u32 s97, 4
    s_cbranch_scc1 ok_50
    s_cmp_ge_u32 s96, 160000
    s_cbranch_scc1 ok_50
    s_sleep 1
    s_branch sw_51
ok_50:
    s_mov_b32 s96, 0
pl_52:
    buffer_load_dword v246, v252, s[40:43], s77 offen sc1
    s_add_u32 s96, s96, 1
    s_waitcnt vmcnt(0)
    v_cmp_ne_u32 vcc, 1, v246
    s_cmp_ge_u32 s96, 20000
    s_cbranch_scc1 pl_52_ok
    s_nop 2
    s_cbranch_vccz pl_52_ok
    s_sleep 1
    s_branch pl_52
pl_52_ok:
fz_opk:
    buffer_load_dwordx4 v[80:83], v15, s[40:43], s12 offen offset:0
    buffer_load_dwordx4 v[84:87], v15, s[40:43], s12 offen offset:1024
    buffer_load_dwordx4 v[88:91], v15, s[40:43], s12 offen offset:2048
    buffer_load_dwordx4 v[92:95], v15, s[40:43], s12 offen offset:3072
    buffer_load_dwordx4 v[96:99], v15, s[40:43], s75 offen offset:0
    buffer_load_dwordx4 v[100:103], v15, s[40:43], s75 offen offset:1024
    buffer_load_dwordx4 v[104:107], v15, s[40:43], s75 offen offset:2048
    buffer_load_dwordx4 v[108:111], v15, s[40:43], s75 offen offset:3072
    buffer_load_dwordx4 v[176:179], v15, s[40:43], s13 offen offset:0
    buffer_load_dwordx4 v[180:183], v15, s[40:43], s13 offen offset:1024
    buffer_load_dwordx4 v[184:187], v15, s[40:43], s13 offen offset:2048
    buffer_load_dwordx4 v[188:191], v15, s[40:43], s13 offen offset:3072
    buffer_load_dwordx4 v[192:195], v15, s[40:43], s76 offen offset:0
    buffer_load_dwordx4 v[196:199], v15, s[40:43], s76 offen offset:1024
    buffer_load_dwordx4 v[200:203], v15, s[40:43], s76 offen offset:2048
    buffer_load_dwordx4 v[204:207], v15, s[40:43], s76 offen offset:3072
    s_mov_b32 s96, 0
    s_waitcnt lgkmcnt(0)
fz_omm:
    s_waitcnt vmcnt(15)
    v_mfma_f32_32x32x16_bf16 v[16:31], v[112:115], v[80:83], 0
    v_max3_u32 v254, v80, v81, v82
    v_max3_u32 v254, v82, v83, v254
    v_mfma_f32_32x32x16_bf16 v[32:47], v[116:119], v[80:83], 0
    s_waitcnt vmcnt(14)
    v_mfma_f32_32x32x16_bf16 v[16:31], v[120:123], v[84:87], v[16:31]
    ds_read_b64_tr_b16 v[112:113], v240 offset:7168
    ds_read_b64_tr_b16 v[114:115], v240 offset:8192
    ds_read_b64_tr_b16 v[116:117], v241 offset:7168
    ds_read_b64_tr_b16 v[118:119], v241 offset:8192
    v_max3_u32 v254, v84, v85, v254
    v_max3_u32 v254, v86, v87, v254
    v_mfma_f32_32x32x16_bf16 v[32:47], v[124:127], v[84:87], v[32:47]
    s_waitcnt vmcnt(13)
    v_mfma_f32_32x32x16_bf16 v[16:31], v[128:131], v[88:91], v[16:31]
    ds_read_b64_tr_b16 v[120:121], v240 offset:9216
    ds_read_b64_tr_b16 v[122:123], v240 offset:10240
    ds_read_b64_tr_b16 v[124:125], v241 offset:9216
    ds_read_b64_tr_b16 v[126:127], v241 offset:10240
    v_max3_u32 v254, v88, v89, v254
    v_max3_u32 v254, v90, v91, v254
    v_mfma_f32_32x32x16_bf16 v[32:47], v[132:135], v[88:91], v[32:47]
    s_waitcnt vmcnt(12)
    v_mfma_f32_32x32x16_bf16 v[16:31], v[136:139], v[92:95], v[16:31]
    ds_read_b64_tr_b16 v[128:129], v240 offset:10752
    ds_read_b64_tr_b16 v[130:131], v240 offset:11776
    ds_read_b64_tr_b16 v[132:133], v241 offset:10752
    ds_read_b64_tr_b16 v[134:135], v241 offset:11776
    v_max3_u32 v254, v92, v93, v254
    v_max3_u32 v254, v94, v95, v254
    v_mfma_f32_32x32x16_bf16 v[32:47], v[140:143], v[92:95], v[32:47]
    s_waitcnt vmcnt(11)
    v_mfma_f32_32x32x16_bf16 v[16:31], v[144:147], v[96:99], v[16:31]
    ds_read_b64_tr_b16 v[136:137], v240 offset:12800
    ds_read_b64_tr_b16 v[138:139], v240 offset:13824
    ds_read_b64_tr_b16 v[140:141], v241 offset:12800
    ds_read_b64_tr_b16 v[142:143], v241 offset:13824
    v_max3_u32 v254, v96, v97, v254
    v_max3_u32 v254, v98, v99, v254
    v_mfma_f32_32x32x16_bf16 v[32:47], v[148:151], v[96:99], v[32:47]
    s_waitcnt vmcnt(10)
    v_mfma_f32_32x32x16_bf16 v[16:31], v[152:155], v[100:103], v[16:31]
    v_max3_u32 v254, v100, v101, v254
    v_max3_u32 v254, v102, v103, v254
    v_mfma_f32_32x32x16_bf16 v[32:47], v[156:159], v[100:103], v[32:47]
    s_waitcnt vmcnt(9)
    v_mfma_f32_32x32x16_bf16 v[16:31], v[160:163], v[104:107], v[16:31]
    v_max3_u32 v254, v104, v105, v254
    v_max3_u32 v254, v106, v107, v254
    v_mfma_f32_32x32x16_bf16 v[32:47], v[164:167], v[104:107], v[32:47]
    s_waitcnt vmcnt(8)
    v_mfma_f32_32x32x16_bf16 v[16:31], v[168:171], v[108:111], v[16:31]
    v_max3_u32 v254, v108, v109, v254
    v_max3_u32 v254, v110, v111, v254
    v_mfma_f32_32x32x16_bf16 v[32:47], v[172:175], v[108:111], v[32:47]
    s_waitcnt vmcnt(7)
    v_mfma_f32_32x32x16_bf16 v[16:31], v[48:51], v[176:179], v[16:31]
    v_max3_u32 v254, v176, v177, v254
    v_max3_u32 v254, v178, v179, v254
    v_mfma_f32_32x32x16_bf16 v[32:47], v[52:55], v[176:179], v[32:47]
    s_waitcnt vmcnt(6)
    v_mfma_f32_32x32x16_bf16 v[16:31], v[56:59], v[180:183], v[16:31]
    v_max3_u32 v254, v180, v181, v254
    v_max3_u32 v254, v182, v183, v254
    v_mfma_f32_32x32x16_bf16 v[32:47], v[60:63], v[180:183], v[32:47]
    s_waitcnt vmcnt(5)
    v_mfma_f32_32x32x16_bf16 v[16:31], v[64:67], v[184:187], v[16:31]
    v_max3_u32 v254, v184, v185, v254
    v_max3_u32 v254, v186, v187, v254
    v_mfma_f32_32x32x16_bf16 v[32:47], v[68:71], v[184:187], v[32:47]
    s_waitcnt vmcnt(4)
    v_mfma_f32_32x32x16_bf16 v[16:31], v[72:75], v[188:191], v[16:31]
    v_max3_u32 v254, v188, v189, v254
    v_max3_u32 v254, v190, v191, v254
    v_mfma_f32_32x32x16_bf16 v[32:47], v[76:79], v[188:191], v[32:47]
    s_waitcnt vmcnt(3) lgkmcnt(12)
    v_mfma_f32_32x32x16_bf16 v[16:31], v[112:115], v[192:195], v[16:31]
    v_max3_u32 v254, v192, v193, v254
    v_max3_u32 v254, v194, v195, v254
    v_mfma_f32_32x32x16_bf16 v[32:47], v[116:119], v[192:195], v[32:47]
    s_waitcnt vmcnt(2) lgkmcnt(8)
    v_mfma_f32_32x32x16_bf16 v[16:31], v[120:123], v[196:199], v[16:31]
    v_max3_u32 v254, v196, v197, v254
    v_max3_u32 v254, v198, v199, v254
    v_mfma_f32_32x32x16_bf16 v[32:47], v[124:127], v[196:199], v[32:47]
    s_waitcnt vmcnt(1) lgkmcnt(4)
    v_mfma_f32_32x32x16_bf16 v[16:31], v[128:131], v[200:203], v[16:31]
    v_max3_u32 v254, v200, v201, v254
    v_max3_u32 v254, v202, v203, v254
    v_mfma_f32_32x32x16_bf16 v[32:47], v[132:135], v[200:203], v[32:47]
    s_waitcnt vmcnt(0) lgkmcnt(0)
    v_mfma_f32_32x32x16_bf16 v[16:31], v[136:139], v[204:207], v[16:31]
    v_max3_u32 v254, v204, v205, v254
    v_max3_u32 v254, v206, v207, v254
    v_mfma_f32_32x32x16_bf16 v[32:47], v[140:143], v[204:207], v[32:47]
    v_cmp_eq_u32 vcc, -1, v254
    s_nop 4
    s_nop 4
    s_cbranch_vccz fz_ook
    s_add_u32 s96, s96, 1
    s_cmp_ge_u32 s96, 2500
    s_cbranch_scc1 fz_ook
    s_sleep 2
    buffer_load_dwordx4 v[80:83], v15, s[40:43], s12 offen offset:0 sc1
    buffer_load_dwordx4 v[84:87], v15, s[40:43], s12 offen offset:1024 sc1
    buffer_load_dwordx4 v[88:91], v15, s[40:43], s12 offen offset:2048 sc1
    buffer_load_dwordx4 v[92:95], v15, s[40:43], s12 offen offset:3072 sc1
    buffer_load_dwordx4 v[96:99], v15, s[40:43], s75 offen offset:0 sc1
    buffer_load_dwordx4 v[100:103], v15, s[40:43], s75 offen offset:1024 sc1
    buffer_load_dwordx4 v[104:107], v15, s[40:43], s75 offen offset:2048 sc1
    buffer_load_dwordx4 v[108:111], v15, s[40:43], s75 offen offset:3072 sc1
    buffer_load_dwordx4 v[176:179], v15, s[40:43], s13 offen offset:0 sc1
    buffer_load_dwordx4 v[180:183], v15, s[40:43], s13 offen offset:1024 sc1
    buffer_load_dwordx4 v[184:187], v15, s[40:43], s13 offen offset:2048 sc1
    buffer_load_dwordx4 v[188:191], v15, s[40:43], s13 offen offset:3072 sc1
    buffer_load_dwordx4 v[192:195], v15, s[40:43], s76 offen offset:0 sc1
    buffer_load_dwordx4 v[196:199], v15, s[40:43], s76 offen offset:1024 sc1
    buffer_load_dwordx4 v[200:203], v15, s[40:43], s76 offen offset:2048 sc1
    buffer_load_dwordx4 v[204:207], v15, s[40:43], s76 offen offset:3072 sc1
    ds_read_b64_tr_b16 v[112:113], v250 offset:0
    ds_read_b64_tr_b16 v[114:115], v250 offset:1024
    ds_read_b64_tr_b16 v[116:117], v251 offset:0
    ds_read_b64_tr_b16 v[118:119], v251 offset:1024
    ds_read_b64_tr_b16 v[120:121], v250 offset:2048
    ds_read_b64_tr_b16 v[122:123], v250 offset:3072
    ds_read_b64_tr_b16 v[124:125], v251 offset:2048
    ds_read_b64_tr_b16 v[126:127], v251 offset:3072
    ds_read_b64_tr_b16 v[128:129], v250 offset:3584
    ds_read_b64_tr_b16 v[130:131], v250 offset:4608
    ds_read_b64_tr_b16 v[132:133], v251 offset:3584
    ds_read_b64_tr_b16 v[134:135], v251 offset:4608
    ds_read_b64_tr_b16 v[136:137], v250 offset:5632
    ds_read_b64_tr_b16 v[138:139], v250 offset:6656
    ds_read_b64_tr_b16 v[140:141], v251 offset:5632
    ds_read_b64_tr_b16 v[142:143], v251 offset:6656
    s_waitcnt lgkmcnt(0)
    s_branch fz_omm
fz_ook:
    ds_write_b128 v242, v[32:35] offset:0
    ds_write_b128 v242, v[36:39] offset:1024
    ds_write_b128 v242, v[40:43] offset:2048
    ds_write_b128 v242, v[44:47] offset:3072
    ds_add_u32 v244, v3 offset:28
    v_pk_fma_f32 v[16:17], v[16:17], v[224:225], v[208:209] op_sel_hi:[1,1,1]
    v_pk_fma_f32 v[18:19], v[18:19], v[226:227], v[210:211] op_sel_hi:[1,1,1]
    v_pk_fma_f32 v[20:21], v[20:21], v[228:229], v[212:213] op_sel_hi:[1,1,1]
    v_pk_fma_f32 v[22:23], v[22:23], v[230:231], v[214:215] op_sel_hi:[1,1,1]
    v_pk_fma_f32 v[24:25], v[24:25], v[232:233], v[216:217] op_sel_hi:[1,1,1]
    v_pk_fma_f32 v[26:27], v[26:27], v[234:235], v[218:219] op_sel_hi:[1,1,1]
    v_pk_fma_f32 v[28:29], v[28:29], v[236:237], v[220:221] op_sel_hi:[1,1,1]
    v_pk_fma_f32 v[30:31], v[30:31], v[238:239], v[222:223] op_sel_hi:[1,1,1]
    s_mov_b32 s96, 0
sw_54:
    ds_read_b32 v246, v245 offset:28
    s_add_u32 s96, s96, 1
    s_waitcnt lgkmcnt(0)
    v_readfirstlane_b32 s97, v246
    s_nop 1
    s_cmp_ge_u32 s97, 2
    s_cbranch_scc1 ok_53
    s_cmp_ge_u32 s96, 160000
    s_cbranch_scc1 ok_53
    s_sleep 1
    s_branch sw_54
ok_53:
    ds_read_b128 v[48:51], v243 offset:0
    ds_read_b128 v[52:55], v243 offset:1024
    ds_read_b128 v[56:59], v243 offset:2048
    ds_read_b128 v[60:63], v243 offset:3072
    s_waitcnt lgkmcnt(3)
    v_pk_fma_f32 v[16:17], v[48:49], v[224:225], v[16:17] op_sel_hi:[1,1,1]
    v_pk_fma_f32 v[18:19], v[50:51], v[226:227], v[18:19] op_sel_hi:[1,1,1]
    s_waitcnt lgkmcnt(2)
    v_pk_fma_f32 v[20:21], v[52:53], v[228:229], v[20:21] op_sel_hi:[1,1,1]
    v_pk_fma_f32 v[22:23], v[54:55], v[230:231], v[22:23] op_sel_hi:[1,1,1]
    s_waitcnt lgkmcnt(1)
    v_pk_fma_f32 v[24:25], v[56:57], v[232:233], v[24:25] op_sel_hi:[1,1,1]
    v_pk_fma_f32 v[26:27], v[58:59], v[234:235], v[26:27] op_sel_hi:[1,1,1]
    s_waitcnt lgkmcnt(0)
    v_pk_fma_f32 v[28:29], v[60:61], v[236:237], v[28:29] op_sel_hi:[1,1,1]
    v_pk_fma_f32 v[30:31], v[62:63], v[238:239], v[30:31] op_sel_hi:[1,1,1]
    v_cvt_pk_bf16_f32 v16, v16, v17
    v_cvt_pk_bf16_f32 v17, v18, v19
    v_cvt_pk_bf16_f32 v18, v20, v21
    v_cvt_pk_bf16_f32 v19, v22, v23
    v_cvt_pk_bf16_f32 v20, v24, v25
    v_cvt_pk_bf16_f32 v21, v26, v27
    v_cvt_pk_bf16_f32 v22, v28, v29
    v_cvt_pk_bf16_f32 v23, v30, v31
    v_permlane32_swap_b32 v16, v18
    v_permlane32_swap_b32 v17, v19
    v_permlane32_swap_b32 v20, v22
    v_permlane32_swap_b32 v21, v23
    buffer_store_dwordx4 v[16:19], v255, s[36:39], s14 offen offset:0
    buffer_store_dwordx4 v[20:23], v255, s[36:39], s14 offen offset:32
fz_gend:
    s_endpgm
fz_gnd:
    ds_add_u32 v2, v3 offset:16
    s_branch fz_gend
fz_end:
    s_endpgm

.section .rodata,"a"
.p2align 6
.amdhsa_kernel fz_kernel
  .amdhsa_next_free_vgpr 256
  .amdhsa_next_free_sgpr 102
  .amdhsa_accum_offset 256
  .amdhsa_group_segment_fixed_size 0
  .amdhsa_kernarg_size 80
  .amdhsa_user_sgpr_count 2
  .amdhsa_user_sgpr_kernarg_segment_ptr 1
  .amdhsa_system_sgpr_workgroup_id_x 1
.end_amdhsa_kernel
```
